```python
import torch

def _softmax(x, axis=-1):
    return torch.softmax(x, dim=axis)
def _gelu(x):
    return torch.nn.functional.gelu(x, approximate="tanh")
def _silu(x):
    return torch.nn.functional.silu(x)
def _sigmoid(x):
    return torch.sigmoid(x)
def _layernorm(x, axis=-1, eps=1e-5):
    m = x.mean(dim=axis, keepdim=True)
    v = x.var(dim=axis, keepdim=True, unbiased=False)
    return (x - m) / torch.sqrt(v + eps)
def _scatter_add(tgt, idx, src, axis=0):
    return tgt.clone().index_add_(axis, idx, src)
def _segment_sum(src, seg, n):
    out = torch.zeros((n,) + src.shape[1:], dtype=src.dtype)
    return out.index_add_(0, seg, src)
def _pad(x, pw):
    flat = tuple(v for pair in reversed(pw) for v in pair)
    return torch.nn.functional.pad(x, flat)

kernel_name = 'parallel_sum__mha_block_cached__geglu_ffn__decode'

def setup_inputs():

    _w = (lambda a: (lambda t: t.to(torch.bfloat16) if t.is_floating_point() else t)(torch.as_tensor(a)))
    def _A_setup():
        B, Sq, D = 1, 1, 512
        H, Sk, Dh = 32, 8192, 128
        return {
            "x": _w((lambda *s: torch.randn(*s, dtype=torch.bfloat16) * 0.05)(B, Sq, D)),
            "k_cache": _w((lambda *s: torch.randn(*s, dtype=torch.bfloat16) * 3.2)(B, H, Sk, Dh)),
            "v_cache": _w((lambda *s: torch.randn(*s, dtype=torch.bfloat16) * 1.6)(B, H, Sk, Dh)),
            "wq": _w((lambda *s: torch.randn(*s, dtype=torch.bfloat16) * 3.2)(D, H * Dh) * (D ** -0.5)),
            "wo": _w((lambda *s: torch.randn(*s, dtype=torch.bfloat16) * 1.6)(H * Dh, D) * ((H * Dh) ** -0.5)),
        }
    _A_in = _A_setup()

    def _B_setup():
        B, S, D, F = 1, 1, 512, 1376
        return {
            "x": _w((lambda *s: torch.randn(*s, dtype=torch.bfloat16) * 0.05)(B, S, D)),
            "w_gate": _w((lambda *s: torch.randn(*s, dtype=torch.bfloat16) * 0.05)(D, F)),
            "w_up": _w((lambda *s: torch.randn(*s, dtype=torch.bfloat16) * 0.05)(D, F)),
            "w_down": _w((lambda *s: torch.randn(*s, dtype=torch.bfloat16) * 0.05)(F, D)),
        }
    _B_in = _B_setup()

    return {
        "A_x": _A_in["x"],
        "A_k_cache": _A_in["k_cache"],
        "A_v_cache": _A_in["v_cache"],
        "A_wq": _A_in["wq"],
        "A_wo": _A_in["wo"],
        "B_x": _B_in["x"],
        "B_w_gate": _B_in["w_gate"],
        "B_w_up": _B_in["w_up"],
        "B_w_down": _B_in["w_down"],
    }

def reference(A_x, A_k_cache, A_v_cache, A_wq, A_wo, B_x, B_w_gate, B_w_up, B_w_down):
    def _A_ref(x, k_cache, v_cache, wq, wo):
        B, Sq, D = x.shape
        H, Dh = 32, 128
        q = (lambda x, *d: x.permute(*d))((x @ wq).reshape(B, Sq, H, Dh), 0, 2, 1, 3)
        scores = torch.einsum("bhqd,bhkd->bhqk", q, k_cache) * (Dh ** -0.5)
        p = _softmax(scores, axis=-1)
        o = torch.einsum("bhqk,bhkd->bhqd", p, v_cache)
        return (lambda x, *d: x.permute(*d))(o, 0, 2, 1, 3).reshape(B, Sq, H * Dh) @ wo

    def _B_ref(x, w_gate, w_up, w_down):
        return (_gelu(x @ w_gate) * (x @ w_up)) @ w_down

    x = A_x
    xn = _layernorm(x, axis=-1)
    return x + _A_ref(xn, A_k_cache, A_v_cache, A_wq, A_wo) + _B_ref(xn, B_w_gate, B_w_up, B_w_down)
```

```asm
; @launch grid=(256,1,1) block=(320,1,1) lds=6144
.amdgcn_target "amdgcn-amd-amdhsa--gfx950"
.text
.globl parallel_sum__mha_block_cached__geglu_ffn__decode_kernel
.p2align 8
.type parallel_sum__mha_block_cached__geglu_ffn__decode_kernel,@function
parallel_sum__mha_block_cached__geglu_ffn__decode_kernel:
    s_cmp_ge_u32 s2, 0x100
    s_cbranch_scc1 L_done
    s_load_dwordx16 s[4:19], s[0:1], 0
    s_load_dwordx8 s[20:27], s[0:1], 64
    v_lshrrev_b32 v1, 6, v0
    v_and_b32 v0, 63, v0
    v_readfirstlane_b32 s3, v1
    s_and_b32 s73, s2, 7
    s_lshr_b32 s74, s2, 3
    s_and_b32 s74, s74, 3
    s_lshl_b32 s68, s73, 2
    s_add_u32 s68, s68, s74
    s_lshr_b32 s69, s2, 5
    s_cmp_eq_u32 s3, 4
    s_cbranch_scc1 L_control
    s_lshl_b32 s74, s68, 21
    s_lshl_b32 s75, s69, 18
    s_add_u32 s74, s74, s75
    v_lshlrev_b32 v1, 4, v0
    s_lshl_b32 s75, s3, 10
    v_add_u32 v1, s75, v1
    s_mov_b32 s76, 0
    s_waitcnt lgkmcnt(0)
    s_add_u32 s32, s6, s74
    s_addc_u32 s33, s7, 0
    s_mov_b32 s34, 0x40000
    s_mov_b32 s35, 0x20000
    buffer_load_dwordx4 v[64:67], v1, s[32:35], s76 offen nt
    s_addk_i32 s76, 0x1000
    buffer_load_dwordx4 v[68:71], v1, s[32:35], s76 offen nt
    s_addk_i32 s76, 0x1000
    s_branch L_stream
L_control:
    s_setprio 3
    s_and_b32 s71, s69, 3
    s_lshr_b32 s72, s69, 2
    v_lshlrev_b32 v1, 4, v0
    v_and_b32 v44, 15, v0
    v_lshlrev_b32 v2, 4, v44
    v_lshrrev_b32 v45, 4, v0
    s_lshl_b32 s75, s69, 7
    v_lshl_add_u32 v3, v0, 1, s75
    v_lshl_add_u32 v4, v45, 17, v2
    s_lshl_b32 s75, s69, 19
    v_add_u32 v4, s75, v4
    s_mul_i32 s73, s68, 43
    s_lshr_b32 s73, s73, 3
    s_add_u32 s74, s68, 1
    s_mul_i32 s74, s74, 43
    s_lshr_b32 s74, s74, 3
    v_subrev_u32 v46, 6, v44
    v_cmp_gt_u32 vcc, 6, v44
    v_min_u32 v46, 5, v46
    s_nop 0
    v_cndmask_b32 v46, v46, v44, vcc
    s_mov_b64 s[90:91], vcc
    v_add_u32 v46, s73, v46
    v_lshlrev_b32 v46, 4, v46
    v_lshlrev_b32 v47, 4, v45
    s_lshl_b32 s75, s69, 6
    v_add_u32 v47, s75, v47
    v_mul_u32_u24 v47, 2752, v47
    v_add_u32 v46, v46, v47
    s_waitcnt lgkmcnt(0)
    s_mov_b32 s28, s4
    s_mov_b32 s29, s5
    s_mov_b32 s30, 0x400
    s_mov_b32 s31, 0x20000
    buffer_load_dwordx4 v[36:39], v1, s[28:31], 0 offen
    buffer_load_ushort v40, v3, s[28:31], 0 offen
    s_load_dword s70, s[26:27], 0
    s_lshl_b32 s75, s68, 8
    s_add_u32 s40, s10, s75
    s_addc_u32 s41, s11, 0
    s_sub_u32 s42, 0x400000, s75
    s_mov_b32 s43, 0x20000
    v_mov_b32 v48, s18
    v_mov_b32 v49, s19
    v_mov_b32 v50, s16
    v_mov_b32 v51, s17
    v_cndmask_b32 v48, v48, v50, s[90:91]
    v_cndmask_b32 v49, v49, v51, s[90:91]
    v_add_co_u32 v6, vcc, v48, v46
    s_nop 1
    v_addc_co_u32 v7, vcc, 0, v49, vcc
    s_mov_b32 s82, 2752
    s_mov_b32 s83, 0
    s_mov_b32 s75, 0
    buffer_load_dwordx4 v[64:67], v4, s[40:43], s75 offen nt
    global_load_dwordx4 v[128:131], v[6:7], off nt
    v_lshl_add_u64 v[6:7], v[6:7], 0, s[82:83]
    s_mov_b32 s75, 8192
    buffer_load_dwordx4 v[68:71], v4, s[40:43], s75 offen nt
    global_load_dwordx4 v[132:135], v[6:7], off nt
    v_lshl_add_u64 v[6:7], v[6:7], 0, s[82:83]
    s_mov_b32 s75, 16384
    buffer_load_dwordx4 v[72:75], v4, s[40:43], s75 offen nt
    global_load_dwordx4 v[136:139], v[6:7], off nt
    v_lshl_add_u64 v[6:7], v[6:7], 0, s[82:83]
    s_mov_b32 s75, 24576
    buffer_load_dwordx4 v[76:79], v4, s[40:43], s75 offen nt
    global_load_dwordx4 v[140:143], v[6:7], off nt
    v_lshl_add_u64 v[6:7], v[6:7], 0, s[82:83]
    s_mov_b32 s75, 32768
    buffer_load_dwordx4 v[80:83], v4, s[40:43], s75 offen nt
    global_load_dwordx4 v[144:147], v[6:7], off nt
    v_lshl_add_u64 v[6:7], v[6:7], 0, s[82:83]
    s_mov_b32 s75, 40960
    buffer_load_dwordx4 v[84:87], v4, s[40:43], s75 offen nt
    global_load_dwordx4 v[148:151], v[6:7], off nt
    v_lshl_add_u64 v[6:7], v[6:7], 0, s[82:83]
    s_mov_b32 s75, 49152
    buffer_load_dwordx4 v[88:91], v4, s[40:43], s75 offen nt
    global_load_dwordx4 v[152:155], v[6:7], off nt
    v_lshl_add_u64 v[6:7], v[6:7], 0, s[82:83]
    s_mov_b32 s75, 57344
    buffer_load_dwordx4 v[92:95], v4, s[40:43], s75 offen nt
    global_load_dwordx4 v[156:159], v[6:7], off nt
    v_lshl_add_u64 v[6:7], v[6:7], 0, s[82:83]
    s_mov_b32 s75, 65536
    buffer_load_dwordx4 v[96:99], v4, s[40:43], s75 offen nt
    global_load_dwordx4 v[160:163], v[6:7], off nt
    v_lshl_add_u64 v[6:7], v[6:7], 0, s[82:83]
    s_mov_b32 s75, 73728
    buffer_load_dwordx4 v[100:103], v4, s[40:43], s75 offen nt
    global_load_dwordx4 v[164:167], v[6:7], off nt
    v_lshl_add_u64 v[6:7], v[6:7], 0, s[82:83]
    s_mov_b32 s75, 81920
    buffer_load_dwordx4 v[104:107], v4, s[40:43], s75 offen nt
    global_load_dwordx4 v[168:171], v[6:7], off nt
    v_lshl_add_u64 v[6:7], v[6:7], 0, s[82:83]
    s_mov_b32 s75, 90112
    buffer_load_dwordx4 v[108:111], v4, s[40:43], s75 offen nt
    global_load_dwordx4 v[172:175], v[6:7], off nt
    v_lshl_add_u64 v[6:7], v[6:7], 0, s[82:83]
    s_mov_b32 s75, 98304
    buffer_load_dwordx4 v[112:115], v4, s[40:43], s75 offen nt
    global_load_dwordx4 v[176:179], v[6:7], off nt
    v_lshl_add_u64 v[6:7], v[6:7], 0, s[82:83]
    s_mov_b32 s75, 106496
    buffer_load_dwordx4 v[116:119], v4, s[40:43], s75 offen nt
    global_load_dwordx4 v[180:183], v[6:7], off nt
    v_lshl_add_u64 v[6:7], v[6:7], 0, s[82:83]
    s_mov_b32 s75, 114688
    buffer_load_dwordx4 v[120:123], v4, s[40:43], s75 offen nt
    global_load_dwordx4 v[184:187], v[6:7], off nt
    v_lshl_add_u64 v[6:7], v[6:7], 0, s[82:83]
    s_mov_b32 s75, 122880
    buffer_load_dwordx4 v[124:127], v4, s[40:43], s75 offen nt
    global_load_dwordx4 v[188:191], v[6:7], off nt
    s_mov_b32 s52, s26
    s_mov_b32 s53, s27
    s_mov_b32 s54, 4194304
    s_mov_b32 s55, 0x20000
    s_mov_b32 s56, s22
    s_mov_b32 s57, s23
    s_mov_b32 s58, 0x400
    s_mov_b32 s59, 0x20000
    s_lshl_b32 s75, s68, 17
    s_lshl_b32 s76, s72, 16
    s_add_u32 s75, s75, s76
    s_lshl_b32 s76, s71, 8
    s_add_u32 s75, s75, s76
    s_add_u32 s44, s12, s75
    s_addc_u32 s45, s13, 0
    s_sub_u32 s46, 0x10000, s76
    s_mov_b32 s47, 0x20000
    s_lshl_b32 s77, s73, 3
    s_mul_i32 s78, s72, 24
    s_add_u32 s77, s77, s78
    s_lshl_b32 s75, s77, 10
    s_add_u32 s75, s75, s76
    s_add_u32 s48, s20, s75
    s_addc_u32 s49, s21, 0
    s_lshl_b32 s79, s74, 3
    s_sub_u32 s79, s79, s77
    s_min_u32 s79, s79, 24
    s_lshl_b32 s79, s79, 10
    s_sub_u32 s50, s79, s76
    s_mov_b32 s51, 0x20000
    v_and_b32 v44, 1, v0
    v_cmp_eq_u32 vcc, 1, v44
    v_mov_b32 v45, 0xffff
    v_mov_b32 v46, 0xffff0000
    v_cndmask_b32 v45, v45, v46, vcc
    v_bfe_u32 v46, v0, 1, 3
    v_cmp_eq_u32 vcc, 0, v46
    s_nop 1
    v_cndmask_b32 v8, 0, v45, vcc
    v_cmp_eq_u32 vcc, 1, v46
    s_nop 1
    v_cndmask_b32 v9, 0, v45, vcc
    v_cmp_eq_u32 vcc, 2, v46
    s_nop 1
    v_cndmask_b32 v10, 0, v45, vcc
    v_cmp_eq_u32 vcc, 3, v46
    s_nop 1
    v_cndmask_b32 v11, 0, v45, vcc
    v_and_b32 v44, 1, v0
    v_cmp_eq_u32 vcc, 1, v44
    v_mov_b32 v45, 0xffff
    v_mov_b32 v46, 0xffff0000
    v_cndmask_b32 v45, v45, v46, vcc
    v_bfe_u32 v46, v0, 1, 3
    v_cmp_eq_u32 vcc, 4, v46
    s_nop 1
    v_cndmask_b32 v12, 0, v45, vcc
    v_cmp_eq_u32 vcc, 5, v46
    s_nop 1
    v_cndmask_b32 v13, 0, v45, vcc
    v_cmp_eq_u32 vcc, 6, v46
    s_nop 1
    v_cndmask_b32 v14, 0, v45, vcc
    v_cmp_eq_u32 vcc, 7, v46
    s_nop 1
    v_cndmask_b32 v15, 0, v45, vcc
    v_lshlrev_b32 v41, 4, v0
    s_getreg_b32 s101, hwreg(HW_REG_XCC_ID)
    s_lshl_b32 s75, s68, 14
    s_add_u32 s75, s75, 65536
    v_add_u32 v41, s75, v41
    s_lshl_b32 s75, s68, 14
    s_lshl_b32 s76, s72, 9
    s_add_u32 s75, s75, s76
    s_add_u32 s75, s75, 589824
    v_lshl_add_u32 v42, v0, 3, s75
    v_and_b32 v44, 7, v0
    s_lshl_b32 s75, s68, 14
    s_add_u32 s75, s75, 590848
    v_lshl_add_u32 v43, v44, 11, s75
    v_bfe_u32 v44, v0, 1, 1
    v_lshrrev_b32 v45, 2, v0
    v_and_b32 v46, 1, v0
    v_lshlrev_b32 v44, 8, v44
    v_lshl_add_u32 v44, v45, 4, v44
    v_lshl_add_u32 v61, v46, 3, v44
    s_waitcnt vmcnt(32)
    v_lshlrev_b32 v44, 16, v36
    v_and_b32 v45, 0xffff0000, v36
    v_lshlrev_b32 v46, 16, v37
    v_and_b32 v47, 0xffff0000, v37
    v_lshlrev_b32 v48, 16, v38
    v_and_b32 v49, 0xffff0000, v38
    v_lshlrev_b32 v50, 16, v39
    v_and_b32 v51, 0xffff0000, v39
    v_add_f32 v52, v44, v45
    v_add_f32 v53, v46, v47
    v_add_f32 v54, v48, v49
    v_add_f32 v55, v50, v51
    v_add_f32 v52, v52, v53
    v_add_f32 v54, v54, v55
    v_add_f32 v52, v52, v54
    s_nop 1
    v_add_f32_dpp v52, v52, v52 row_mirror row_mask:0xf bank_mask:0xf
    s_nop 1
    v_add_f32_dpp v52, v52, v52 row_half_mirror row_mask:0xf bank_mask:0xf
    s_nop 1
    v_add_f32_dpp v52, v52, v52 quad_perm:[2,3,0,1] row_mask:0xf bank_mask:0xf
    s_nop 1
    v_add_f32_dpp v52, v52, v52 quad_perm:[1,0,3,2] row_mask:0xf bank_mask:0xf
    s_nop 1
    v_add_f32_dpp v52, v52, v52 row_bcast:15 row_mask:0xa bank_mask:0xf
    s_nop 1
    v_add_f32_dpp v52, v52, v52 row_bcast:31 row_mask:0xc bank_mask:0xf
    s_nop 0
    v_readlane_b32 s75, v52, 63
    v_mov_b32 v53, 0x3b000000
    s_nop 0
    v_mul_f32 v53, s75, v53
    v_sub_f32 v44, v44, v53
    v_sub_f32 v45, v45, v53
    v_sub_f32 v46, v46, v53
    v_sub_f32 v47, v47, v53
    v_sub_f32 v48, v48, v53
    v_sub_f32 v49, v49, v53
    v_sub_f32 v50, v50, v53
    v_sub_f32 v51, v51, v53
    v_mul_f32 v52, v44, v44
    v_mul_f32 v54, v45, v45
    v_fmac_f32 v52, v46, v46
    v_fmac_f32 v54, v47, v47
    v_fmac_f32 v52, v48, v48
    v_fmac_f32 v54, v49, v49
    v_fmac_f32 v52, v50, v50
    v_fmac_f32 v54, v51, v51
    v_add_f32 v52, v52, v54
    s_nop 1
    v_add_f32_dpp v52, v52, v52 row_mirror row_mask:0xf bank_mask:0xf
    s_nop 1
    v_add_f32_dpp v52, v52, v52 row_half_mirror row_mask:0xf bank_mask:0xf
    s_nop 1
    v_add_f32_dpp v52, v52, v52 quad_perm:[2,3,0,1] row_mask:0xf bank_mask:0xf
    s_nop 1
    v_add_f32_dpp v52, v52, v52 quad_perm:[1,0,3,2] row_mask:0xf bank_mask:0xf
    s_nop 1
    v_add_f32_dpp v52, v52, v52 row_bcast:15 row_mask:0xa bank_mask:0xf
    s_nop 1
    v_add_f32_dpp v52, v52, v52 row_bcast:31 row_mask:0xc bank_mask:0xf
    s_nop 0
    v_readlane_b32 s75, v52, 63
    v_mov_b32 v54, 0x3b000000
    s_nop 0
    v_mul_f32 v54, s75, v54
    v_cvt_pk_bf16_f32 v53, v53, v53
    v_and_b32 v53, 0xffff0000, v53
    v_cvt_pk_bf16_f32 v54, v54, v54
    v_and_b32 v54, 0xffff0000, v54
    v_add_f32 v54, 0x3727c5ac, v54
    v_cvt_pk_bf16_f32 v54, v54, v54
    v_and_b32 v54, 0xffff0000, v54
    v_sqrt_f32 v54, v54
    s_nop 0
    v_cvt_pk_bf16_f32 v54, v54, v54
    v_and_b32 v54, 0xffff0000, v54
    v_rcp_f32 v55, v54
    v_lshlrev_b32 v56, 16, v40
    v_sub_f32 v56, v56, v53
    v_cvt_pk_bf16_f32 v56, v56, v56
    v_and_b32 v56, 0xffff0000, v56
    v_mul_f32 v44, v56, v55
    v_fma_f32 v57, -v44, v54, v56
    v_fma_f32 v44, v57, v55, v44
    v_cvt_pk_bf16_f32 v40, v44, v44
    s_waitcnt lgkmcnt(0)
    s_mul_i32 s70, s70, 0x19660d
    s_add_u32 s70, s70, 0x3c6ef35f
    v_and_b32_dpp v16, v40, v8 row_newbcast:0 row_mask:0xf bank_mask:0xf
    v_and_b32_dpp v17, v40, v9 row_newbcast:0 row_mask:0xf bank_mask:0xf
    v_and_b32_dpp v18, v40, v10 row_newbcast:0 row_mask:0xf bank_mask:0xf
    v_and_b32_dpp v19, v40, v11 row_newbcast:0 row_mask:0xf bank_mask:0xf
    v_and_b32_dpp v24, v40, v12 row_newbcast:0 row_mask:0xf bank_mask:0xf
    v_and_b32_dpp v25, v40, v13 row_newbcast:0 row_mask:0xf bank_mask:0xf
    v_and_b32_dpp v26, v40, v14 row_newbcast:0 row_mask:0xf bank_mask:0xf
    v_and_b32_dpp v27, v40, v15 row_newbcast:0 row_mask:0xf bank_mask:0xf
    v_and_b32_dpp v20, v40, v8 row_newbcast:1 row_mask:0xf bank_mask:0xf
    v_and_b32_dpp v21, v40, v9 row_newbcast:1 row_mask:0xf bank_mask:0xf
    v_and_b32_dpp v22, v40, v10 row_newbcast:1 row_mask:0xf bank_mask:0xf
    v_and_b32_dpp v23, v40, v11 row_newbcast:1 row_mask:0xf bank_mask:0xf
    v_and_b32_dpp v28, v40, v12 row_newbcast:1 row_mask:0xf bank_mask:0xf
    v_and_b32_dpp v29, v40, v13 row_newbcast:1 row_mask:0xf bank_mask:0xf
    v_and_b32_dpp v30, v40, v14 row_newbcast:1 row_mask:0xf bank_mask:0xf
    v_and_b32_dpp v31, v40, v15 row_newbcast:1 row_mask:0xf bank_mask:0xf
    s_waitcnt vmcnt(30)
    v_mfma_f32_16x16x32_bf16 v[32:35], v[16:19], v[64:67], 0
    v_mfma_f32_16x16x32_bf16 v[32:35], v[24:27], v[128:131], v[32:35]
    v_and_b32_dpp v16, v40, v8 row_newbcast:2 row_mask:0xf bank_mask:0xf
    v_and_b32_dpp v17, v40, v9 row_newbcast:2 row_mask:0xf bank_mask:0xf
    v_and_b32_dpp v18, v40, v10 row_newbcast:2 row_mask:0xf bank_mask:0xf
    v_and_b32_dpp v19, v40, v11 row_newbcast:2 row_mask:0xf bank_mask:0xf
    v_and_b32_dpp v24, v40, v12 row_newbcast:2 row_mask:0xf bank_mask:0xf
    v_and_b32_dpp v25, v40, v13 row_newbcast:2 row_mask:0xf bank_mask:0xf
    v_and_b32_dpp v26, v40, v14 row_newbcast:2 row_mask:0xf bank_mask:0xf
    v_and_b32_dpp v27, v40, v15 row_newbcast:2 row_mask:0xf bank_mask:0xf
    s_waitcnt vmcnt(28)
    v_mfma_f32_16x16x32_bf16 v[32:35], v[20:23], v[68:71], v[32:35]
    v_mfma_f32_16x16x32_bf16 v[32:35], v[28:31], v[132:135], v[32:35]
    v_and_b32_dpp v20, v40, v8 row_newbcast:3 row_mask:0xf bank_mask:0xf
    v_and_b32_dpp v21, v40, v9 row_newbcast:3 row_mask:0xf bank_mask:0xf
    v_and_b32_dpp v22, v40, v10 row_newbcast:3 row_mask:0xf bank_mask:0xf
    v_and_b32_dpp v23, v40, v11 row_newbcast:3 row_mask:0xf bank_mask:0xf
    v_and_b32_dpp v28, v40, v12 row_newbcast:3 row_mask:0xf bank_mask:0xf
    v_and_b32_dpp v29, v40, v13 row_newbcast:3 row_mask:0xf bank_mask:0xf
    v_and_b32_dpp v30, v40, v14 row_newbcast:3 row_mask:0xf bank_mask:0xf
    v_and_b32_dpp v31, v40, v15 row_newbcast:3 row_mask:0xf bank_mask:0xf
    s_waitcnt vmcnt(26)
    v_mfma_f32_16x16x32_bf16 v[32:35], v[16:19], v[72:75], v[32:35]
    v_mfma_f32_16x16x32_bf16 v[32:35], v[24:27], v[136:139], v[32:35]
    v_and_b32_dpp v16, v40, v8 row_newbcast:4 row_mask:0xf bank_mask:0xf
    v_and_b32_dpp v17, v40, v9 row_newbcast:4 row_mask:0xf bank_mask:0xf
    v_and_b32_dpp v18, v40, v10 row_newbcast:4 row_mask:0xf bank_mask:0xf
    v_and_b32_dpp v19, v40, v11 row_newbcast:4 row_mask:0xf bank_mask:0xf
    v_and_b32_dpp v24, v40, v12 row_newbcast:4 row_mask:0xf bank_mask:0xf
    v_and_b32_dpp v25, v40, v13 row_newbcast:4 row_mask:0xf bank_mask:0xf
    v_and_b32_dpp v26, v40, v14 row_newbcast:4 row_mask:0xf bank_mask:0xf
    v_and_b32_dpp v27, v40, v15 row_newbcast:4 row_mask:0xf bank_mask:0xf
    s_waitcnt vmcnt(24)
    v_mfma_f32_16x16x32_bf16 v[32:35], v[20:23], v[76:79], v[32:35]
    v_mfma_f32_16x16x32_bf16 v[32:35], v[28:31], v[140:143], v[32:35]
    v_and_b32_dpp v20, v40, v8 row_newbcast:5 row_mask:0xf bank_mask:0xf
    v_and_b32_dpp v21, v40, v9 row_newbcast:5 row_mask:0xf bank_mask:0xf
    v_and_b32_dpp v22, v40, v10 row_newbcast:5 row_mask:0xf bank_mask:0xf
    v_and_b32_dpp v23, v40, v11 row_newbcast:5 row_mask:0xf bank_mask:0xf
    v_and_b32_dpp v28, v40, v12 row_newbcast:5 row_mask:0xf bank_mask:0xf
    v_and_b32_dpp v29, v40, v13 row_newbcast:5 row_mask:0xf bank_mask:0xf
    v_and_b32_dpp v30, v40, v14 row_newbcast:5 row_mask:0xf bank_mask:0xf
    v_and_b32_dpp v31, v40, v15 row_newbcast:5 row_mask:0xf bank_mask:0xf
    s_waitcnt vmcnt(22)
    v_mfma_f32_16x16x32_bf16 v[32:35], v[16:19], v[80:83], v[32:35]
    v_mfma_f32_16x16x32_bf16 v[32:35], v[24:27], v[144:147], v[32:35]
    v_and_b32_dpp v16, v40, v8 row_newbcast:6 row_mask:0xf bank_mask:0xf
    v_and_b32_dpp v17, v40, v9 row_newbcast:6 row_mask:0xf bank_mask:0xf
    v_and_b32_dpp v18, v40, v10 row_newbcast:6 row_mask:0xf bank_mask:0xf
    v_and_b32_dpp v19, v40, v11 row_newbcast:6 row_mask:0xf bank_mask:0xf
    v_and_b32_dpp v24, v40, v12 row_newbcast:6 row_mask:0xf bank_mask:0xf
    v_and_b32_dpp v25, v40, v13 row_newbcast:6 row_mask:0xf bank_mask:0xf
    v_and_b32_dpp v26, v40, v14 row_newbcast:6 row_mask:0xf bank_mask:0xf
    v_and_b32_dpp v27, v40, v15 row_newbcast:6 row_mask:0xf bank_mask:0xf
    s_waitcnt vmcnt(20)
    v_mfma_f32_16x16x32_bf16 v[32:35], v[20:23], v[84:87], v[32:35]
    v_mfma_f32_16x16x32_bf16 v[32:35], v[28:31], v[148:151], v[32:35]
    v_and_b32_dpp v20, v40, v8 row_newbcast:7 row_mask:0xf bank_mask:0xf
    v_and_b32_dpp v21, v40, v9 row_newbcast:7 row_mask:0xf bank_mask:0xf
    v_and_b32_dpp v22, v40, v10 row_newbcast:7 row_mask:0xf bank_mask:0xf
    v_and_b32_dpp v23, v40, v11 row_newbcast:7 row_mask:0xf bank_mask:0xf
    v_and_b32_dpp v28, v40, v12 row_newbcast:7 row_mask:0xf bank_mask:0xf
    v_and_b32_dpp v29, v40, v13 row_newbcast:7 row_mask:0xf bank_mask:0xf
    v_and_b32_dpp v30, v40, v14 row_newbcast:7 row_mask:0xf bank_mask:0xf
    v_and_b32_dpp v31, v40, v15 row_newbcast:7 row_mask:0xf bank_mask:0xf
    s_waitcnt vmcnt(18)
    v_mfma_f32_16x16x32_bf16 v[32:35], v[16:19], v[88:91], v[32:35]
    v_mfma_f32_16x16x32_bf16 v[32:35], v[24:27], v[152:155], v[32:35]
    v_and_b32_dpp v16, v40, v8 row_newbcast:8 row_mask:0xf bank_mask:0xf
    v_and_b32_dpp v17, v40, v9 row_newbcast:8 row_mask:0xf bank_mask:0xf
    v_and_b32_dpp v18, v40, v10 row_newbcast:8 row_mask:0xf bank_mask:0xf
    v_and_b32_dpp v19, v40, v11 row_newbcast:8 row_mask:0xf bank_mask:0xf
    v_and_b32_dpp v24, v40, v12 row_newbcast:8 row_mask:0xf bank_mask:0xf
    v_and_b32_dpp v25, v40, v13 row_newbcast:8 row_mask:0xf bank_mask:0xf
    v_and_b32_dpp v26, v40, v14 row_newbcast:8 row_mask:0xf bank_mask:0xf
    v_and_b32_dpp v27, v40, v15 row_newbcast:8 row_mask:0xf bank_mask:0xf
    s_waitcnt vmcnt(16)
    v_mfma_f32_16x16x32_bf16 v[32:35], v[20:23], v[92:95], v[32:35]
    v_mfma_f32_16x16x32_bf16 v[32:35], v[28:31], v[156:159], v[32:35]
    v_and_b32_dpp v20, v40, v8 row_newbcast:9 row_mask:0xf bank_mask:0xf
    v_and_b32_dpp v21, v40, v9 row_newbcast:9 row_mask:0xf bank_mask:0xf
    v_and_b32_dpp v22, v40, v10 row_newbcast:9 row_mask:0xf bank_mask:0xf
    v_and_b32_dpp v23, v40, v11 row_newbcast:9 row_mask:0xf bank_mask:0xf
    v_and_b32_dpp v28, v40, v12 row_newbcast:9 row_mask:0xf bank_mask:0xf
    v_and_b32_dpp v29, v40, v13 row_newbcast:9 row_mask:0xf bank_mask:0xf
    v_and_b32_dpp v30, v40, v14 row_newbcast:9 row_mask:0xf bank_mask:0xf
    v_and_b32_dpp v31, v40, v15 row_newbcast:9 row_mask:0xf bank_mask:0xf
    s_waitcnt vmcnt(14)
    v_mfma_f32_16x16x32_bf16 v[32:35], v[16:19], v[96:99], v[32:35]
    v_mfma_f32_16x16x32_bf16 v[32:35], v[24:27], v[160:163], v[32:35]
    v_and_b32_dpp v16, v40, v8 row_newbcast:10 row_mask:0xf bank_mask:0xf
    v_and_b32_dpp v17, v40, v9 row_newbcast:10 row_mask:0xf bank_mask:0xf
    v_and_b32_dpp v18, v40, v10 row_newbcast:10 row_mask:0xf bank_mask:0xf
    v_and_b32_dpp v19, v40, v11 row_newbcast:10 row_mask:0xf bank_mask:0xf
    v_and_b32_dpp v24, v40, v12 row_newbcast:10 row_mask:0xf bank_mask:0xf
    v_and_b32_dpp v25, v40, v13 row_newbcast:10 row_mask:0xf bank_mask:0xf
    v_and_b32_dpp v26, v40, v14 row_newbcast:10 row_mask:0xf bank_mask:0xf
    v_and_b32_dpp v27, v40, v15 row_newbcast:10 row_mask:0xf bank_mask:0xf
    s_waitcnt vmcnt(12)
    v_mfma_f32_16x16x32_bf16 v[32:35], v[20:23], v[100:103], v[32:35]
    v_mfma_f32_16x16x32_bf16 v[32:35], v[28:31], v[164:167], v[32:35]
    v_and_b32_dpp v20, v40, v8 row_newbcast:11 row_mask:0xf bank_mask:0xf
    v_and_b32_dpp v21, v40, v9 row_newbcast:11 row_mask:0xf bank_mask:0xf
    v_and_b32_dpp v22, v40, v10 row_newbcast:11 row_mask:0xf bank_mask:0xf
    v_and_b32_dpp v23, v40, v11 row_newbcast:11 row_mask:0xf bank_mask:0xf
    v_and_b32_dpp v28, v40, v12 row_newbcast:11 row_mask:0xf bank_mask:0xf
    v_and_b32_dpp v29, v40, v13 row_newbcast:11 row_mask:0xf bank_mask:0xf
    v_and_b32_dpp v30, v40, v14 row_newbcast:11 row_mask:0xf bank_mask:0xf
    v_and_b32_dpp v31, v40, v15 row_newbcast:11 row_mask:0xf bank_mask:0xf
    s_waitcnt vmcnt(10)
    v_mfma_f32_16x16x32_bf16 v[32:35], v[16:19], v[104:107], v[32:35]
    v_mfma_f32_16x16x32_bf16 v[32:35], v[24:27], v[168:171], v[32:35]
    v_and_b32_dpp v16, v40, v8 row_newbcast:12 row_mask:0xf bank_mask:0xf
    v_and_b32_dpp v17, v40, v9 row_newbcast:12 row_mask:0xf bank_mask:0xf
    v_and_b32_dpp v18, v40, v10 row_newbcast:12 row_mask:0xf bank_mask:0xf
    v_and_b32_dpp v19, v40, v11 row_newbcast:12 row_mask:0xf bank_mask:0xf
    v_and_b32_dpp v24, v40, v12 row_newbcast:12 row_mask:0xf bank_mask:0xf
    v_and_b32_dpp v25, v40, v13 row_newbcast:12 row_mask:0xf bank_mask:0xf
    v_and_b32_dpp v26, v40, v14 row_newbcast:12 row_mask:0xf bank_mask:0xf
    v_and_b32_dpp v27, v40, v15 row_newbcast:12 row_mask:0xf bank_mask:0xf
    s_waitcnt vmcnt(8)
    v_mfma_f32_16x16x32_bf16 v[32:35], v[20:23], v[108:111], v[32:35]
    v_mfma_f32_16x16x32_bf16 v[32:35], v[28:31], v[172:175], v[32:35]
    v_and_b32_dpp v20, v40, v8 row_newbcast:13 row_mask:0xf bank_mask:0xf
    v_and_b32_dpp v21, v40, v9 row_newbcast:13 row_mask:0xf bank_mask:0xf
    v_and_b32_dpp v22, v40, v10 row_newbcast:13 row_mask:0xf bank_mask:0xf
    v_and_b32_dpp v23, v40, v11 row_newbcast:13 row_mask:0xf bank_mask:0xf
    v_and_b32_dpp v28, v40, v12 row_newbcast:13 row_mask:0xf bank_mask:0xf
    v_and_b32_dpp v29, v40, v13 row_newbcast:13 row_mask:0xf bank_mask:0xf
    v_and_b32_dpp v30, v40, v14 row_newbcast:13 row_mask:0xf bank_mask:0xf
    v_and_b32_dpp v31, v40, v15 row_newbcast:13 row_mask:0xf bank_mask:0xf
    s_waitcnt vmcnt(6)
    v_mfma_f32_16x16x32_bf16 v[32:35], v[16:19], v[112:115], v[32:35]
    v_mfma_f32_16x16x32_bf16 v[32:35], v[24:27], v[176:179], v[32:35]
    v_and_b32_dpp v16, v40, v8 row_newbcast:14 row_mask:0xf bank_mask:0xf
    v_and_b32_dpp v17, v40, v9 row_newbcast:14 row_mask:0xf bank_mask:0xf
    v_and_b32_dpp v18, v40, v10 row_newbcast:14 row_mask:0xf bank_mask:0xf
    v_and_b32_dpp v19, v40, v11 row_newbcast:14 row_mask:0xf bank_mask:0xf
    v_and_b32_dpp v24, v40, v12 row_newbcast:14 row_mask:0xf bank_mask:0xf
    v_and_b32_dpp v25, v40, v13 row_newbcast:14 row_mask:0xf bank_mask:0xf
    v_and_b32_dpp v26, v40, v14 row_newbcast:14 row_mask:0xf bank_mask:0xf
    v_and_b32_dpp v27, v40, v15 row_newbcast:14 row_mask:0xf bank_mask:0xf
    s_waitcnt vmcnt(4)
    v_mfma_f32_16x16x32_bf16 v[32:35], v[20:23], v[116:119], v[32:35]
    v_mfma_f32_16x16x32_bf16 v[32:35], v[28:31], v[180:183], v[32:35]
    v_and_b32_dpp v20, v40, v8 row_newbcast:15 row_mask:0xf bank_mask:0xf
    v_and_b32_dpp v21, v40, v9 row_newbcast:15 row_mask:0xf bank_mask:0xf
    v_and_b32_dpp v22, v40, v10 row_newbcast:15 row_mask:0xf bank_mask:0xf
    v_and_b32_dpp v23, v40, v11 row_newbcast:15 row_mask:0xf bank_mask:0xf
    v_and_b32_dpp v28, v40, v12 row_newbcast:15 row_mask:0xf bank_mask:0xf
    v_and_b32_dpp v29, v40, v13 row_newbcast:15 row_mask:0xf bank_mask:0xf
    v_and_b32_dpp v30, v40, v14 row_newbcast:15 row_mask:0xf bank_mask:0xf
    v_and_b32_dpp v31, v40, v15 row_newbcast:15 row_mask:0xf bank_mask:0xf
    s_waitcnt vmcnt(2)
    v_mfma_f32_16x16x32_bf16 v[32:35], v[16:19], v[120:123], v[32:35]
    v_mfma_f32_16x16x32_bf16 v[32:35], v[24:27], v[184:187], v[32:35]
    s_waitcnt vmcnt(0)
    v_mfma_f32_16x16x32_bf16 v[32:35], v[20:23], v[124:127], v[32:35]
    v_mfma_f32_16x16x32_bf16 v[32:35], v[28:31], v[188:191], v[32:35]
    v_mov_b32 v209, s70
    v_mov_b32 v211, s70
    v_mov_b32 v213, s70
    v_mov_b32 v215, s70
    s_lshl_b32 s77, s69, 11
    s_nop 2
    v_mov_b32 v208, v32
    v_mov_b32 v210, v33
    v_mov_b32 v212, v34
    v_mov_b32 v214, v35
    v_writelane_b32 v214, s101, 63
    buffer_store_dwordx4 v[208:211], v41, s[52:55], s77 offen
    buffer_store_dwordx4 v[212:215], v41, s[52:55], s77 offen offset:1024
    s_add_u32 s77, s77, 2097152
    v_mov_b32 v52, 0
    v_mov_b32 v53, 0
    v_mov_b32 v54, 0
    v_mov_b32 v55, 0
    v_and_b32 v56, 3, v0
    v_lshlrev_b32 v60, 4, v56
    ds_write_b128 v60, v[52:55] offset:5120
    s_waitcnt vmcnt(0)
    s_mov_b32 s76, 200000
    s_mov_b32 s83, 0
    s_add_u32 s75, s83, 0
    buffer_load_dwordx4 v[64:67], v41, s[52:55], s75 offen sc1
    buffer_load_dwordx4 v[68:71], v41, s[52:55], s75 offen offset:1024 sc1
    s_add_u32 s75, s83, 2048
    buffer_load_dwordx4 v[72:75], v41, s[52:55], s75 offen sc1
    buffer_load_dwordx4 v[76:79], v41, s[52:55], s75 offen offset:1024 sc1
    s_add_u32 s75, s83, 4096
    buffer_load_dwordx4 v[80:83], v41, s[52:55], s75 offen sc1
    buffer_load_dwordx4 v[84:87], v41, s[52:55], s75 offen offset:1024 sc1
    s_add_u32 s75, s83, 6144
    buffer_load_dwordx4 v[88:91], v41, s[52:55], s75 offen sc1
    buffer_load_dwordx4 v[92:95], v41, s[52:55], s75 offen offset:1024 sc1
    s_add_u32 s75, s83, 8192
    buffer_load_dwordx4 v[96:99], v41, s[52:55], s75 offen sc1
    buffer_load_dwordx4 v[100:103], v41, s[52:55], s75 offen offset:1024 sc1
    s_add_u32 s75, s83, 10240
    buffer_load_dwordx4 v[104:107], v41, s[52:55], s75 offen sc1
    buffer_load_dwordx4 v[108:111], v41, s[52:55], s75 offen offset:1024 sc1
    s_add_u32 s75, s83, 12288
    buffer_load_dwordx4 v[112:115], v41, s[52:55], s75 offen sc1
    buffer_load_dwordx4 v[116:119], v41, s[52:55], s75 offen offset:1024 sc1
    s_add_u32 s75, s83, 14336
    buffer_load_dwordx4 v[120:123], v41, s[52:55], s75 offen sc1
    buffer_load_dwordx4 v[124:127], v41, s[52:55], s75 offen offset:1024 sc1
L_g0:
    s_waitcnt vmcnt(0)
    v_min3_u32 v44, v65, v67, v69
    v_max3_u32 v45, v65, v67, v69
    v_min3_u32 v44, v44, v71, v73
    v_max3_u32 v45, v45, v71, v73
    v_min3_u32 v44, v44, v75, v77
    v_max3_u32 v45, v45, v75, v77
    v_min3_u32 v44, v44, v79, v81
    v_max3_u32 v45, v45, v79, v81
    v_min3_u32 v44, v44, v83, v85
    v_max3_u32 v45, v45, v83, v85
    v_min3_u32 v44, v44, v87, v89
    v_max3_u32 v45, v45, v87, v89
    v_min3_u32 v44, v44, v91, v93
    v_max3_u32 v45, v45, v91, v93
    v_min3_u32 v44, v44, v95, v97
    v_max3_u32 v45, v45, v95, v97
    v_min3_u32 v44, v44, v99, v101
    v_max3_u32 v45, v45, v99, v101
    v_min3_u32 v44, v44, v103, v105
    v_max3_u32 v45, v45, v103, v105
    v_min3_u32 v44, v44, v107, v109
    v_max3_u32 v45, v45, v107, v109
    v_min3_u32 v44, v44, v111, v113
    v_max3_u32 v45, v45, v111, v113
    v_min3_u32 v44, v44, v115, v117
    v_max3_u32 v45, v45, v115, v117
    v_min3_u32 v44, v44, v119, v121
    v_max3_u32 v45, v45, v119, v121
    v_min3_u32 v44, v44, v123, v125
    v_max3_u32 v45, v45, v123, v125
    v_min_u32 v44, v44, v127
    v_max_u32 v45, v45, v127
    v_cmp_ne_u32 vcc, s70, v44
    v_cmp_ne_u32 s[84:85], s70, v45
    s_or_b64 vcc, vcc, s[84:85]
    s_cmp_eq_u64 vcc, 0
    s_cbranch_scc1 L_g0_ok
    s_sub_u32 s76, s76, 1
    s_cbranch_scc1 L_g0_ok
    s_cmp_gt_u32 s76, 199976
    s_cbranch_scc1 L_g0_again
    s_cmp_eq_u32 s76, 199976
    s_cbranch_scc0 L_g0_flip
    buffer_store_dwordx4 v[208:211], v41, s[52:55], s77 offen sc1
    buffer_store_dwordx4 v[212:215], v41, s[52:55], s77 offen offset:1024 sc1
L_g0_flip:
    s_xor_b32 s83, s83, 2097152
L_g0_again:
    s_sleep 1
    s_add_u32 s75, s83, 0
    buffer_load_dwordx4 v[64:67], v41, s[52:55], s75 offen sc1
    buffer_load_dwordx4 v[68:71], v41, s[52:55], s75 offen offset:1024 sc1
    s_add_u32 s75, s83, 2048
    buffer_load_dwordx4 v[72:75], v41, s[52:55], s75 offen sc1
    buffer_load_dwordx4 v[76:79], v41, s[52:55], s75 offen offset:1024 sc1
    s_add_u32 s75, s83, 4096
    buffer_load_dwordx4 v[80:83], v41, s[52:55], s75 offen sc1
    buffer_load_dwordx4 v[84:87], v41, s[52:55], s75 offen offset:1024 sc1
    s_add_u32 s75, s83, 6144
    buffer_load_dwordx4 v[88:91], v41, s[52:55], s75 offen sc1
    buffer_load_dwordx4 v[92:95], v41, s[52:55], s75 offen offset:1024 sc1
    s_add_u32 s75, s83, 8192
    buffer_load_dwordx4 v[96:99], v41, s[52:55], s75 offen sc1
    buffer_load_dwordx4 v[100:103], v41, s[52:55], s75 offen offset:1024 sc1
    s_add_u32 s75, s83, 10240
    buffer_load_dwordx4 v[104:107], v41, s[52:55], s75 offen sc1
    buffer_load_dwordx4 v[108:111], v41, s[52:55], s75 offen offset:1024 sc1
    s_add_u32 s75, s83, 12288
    buffer_load_dwordx4 v[112:115], v41, s[52:55], s75 offen sc1
    buffer_load_dwordx4 v[116:119], v41, s[52:55], s75 offen offset:1024 sc1
    s_add_u32 s75, s83, 14336
    buffer_load_dwordx4 v[120:123], v41, s[52:55], s75 offen sc1
    buffer_load_dwordx4 v[124:127], v41, s[52:55], s75 offen offset:1024 sc1
    s_branch L_g0
L_g0_ok:
    v_min3_u32 v44, v70, v78, v86
    v_max3_u32 v45, v70, v78, v86
    v_min3_u32 v44, v44, v94, v102
    v_max3_u32 v45, v45, v94, v102
    v_min3_u32 v44, v44, v110, v118
    v_max3_u32 v45, v45, v110, v118
    v_min_u32 v44, v44, v126
    v_max_u32 v45, v45, v126
    v_xor_b32 v44, s101, v44
    v_xor_b32 v45, s101, v45
    v_or_b32 v44, v44, v45
    s_nop 0
    v_readlane_b32 s75, v44, 63
    s_nop 0
    s_cmp_eq_u32 s75, 0
    s_cselect_b32 s100, 1, 0
    s_cmp_eq_u32 s100, 1
    s_cbranch_scc1 L_g0_nob
    buffer_store_dwordx4 v[208:211], v41, s[52:55], s77 offen sc1
    buffer_store_dwordx4 v[212:215], v41, s[52:55], s77 offen offset:1024 sc1
L_g0_nob:
    v_add_f32 v196, v64, v72
    v_add_f32 v197, v66, v74
    v_add_f32 v198, v68, v76
    v_add_f32 v199, v70, v78
    v_add_f32 v196, v196, v80
    v_add_f32 v197, v197, v82
    v_add_f32 v198, v198, v84
    v_add_f32 v199, v199, v86
    v_add_f32 v196, v196, v88
    v_add_f32 v197, v197, v90
    v_add_f32 v198, v198, v92
    v_add_f32 v199, v199, v94
    v_add_f32 v196, v196, v96
    v_add_f32 v197, v197, v98
    v_add_f32 v198, v198, v100
    v_add_f32 v199, v199, v102
    v_add_f32 v196, v196, v104
    v_add_f32 v197, v197, v106
    v_add_f32 v198, v198, v108
    v_add_f32 v199, v199, v110
    v_add_f32 v196, v196, v112
    v_add_f32 v197, v197, v114
    v_add_f32 v198, v198, v116
    v_add_f32 v199, v199, v118
    v_add_f32 v196, v196, v120
    v_add_f32 v197, v197, v122
    v_add_f32 v198, v198, v124
    v_add_f32 v199, v199, v126
    v_cvt_pk_bf16_f32 v44, v196, v197
    v_cvt_pk_bf16_f32 v45, v198, v199
    v_lshrrev_b32 v46, 5, v0
    v_bfe_u32 v47, v0, 4, 1
    v_lshl_add_u32 v46, v46, 8, v2
    v_lshl_add_u32 v46, v47, 3, v46
    ds_write_b64 v46, v[44:45] offset:0
    s_waitcnt lgkmcnt(0)
    s_barrier
    v_cvt_pk_bf16_f32 v44, v196, v196
    v_and_b32 v44, 0xffff0000, v44
    v_cvt_pk_bf16_f32 v45, v197, v197
    v_and_b32 v45, 0xffff0000, v45
    v_cvt_pk_bf16_f32 v46, v198, v198
    v_and_b32 v46, 0xffff0000, v46
    v_cvt_pk_bf16_f32 v47, v199, v199
    v_and_b32 v47, 0xffff0000, v47
    v_mov_b32_dpp v48, v44 row_shl:6 row_mask:0xf bank_mask:0xf
    v_mov_b32_dpp v49, v45 row_shl:6 row_mask:0xf bank_mask:0xf
    v_mov_b32_dpp v50, v46 row_shl:6 row_mask:0xf bank_mask:0xf
    v_mov_b32_dpp v51, v47 row_shl:6 row_mask:0xf bank_mask:0xf
    v_mul_f32 v52, v44, v44
    v_mul_f32 v53, v45, v45
    v_mul_f32 v54, v46, v46
    v_mul_f32 v55, v47, v47
    v_mul_f32 v52, v52, v44
    v_mul_f32 v53, v53, v45
    v_mul_f32 v54, v54, v46
    v_mul_f32 v55, v55, v47
    v_mul_f32 v52, 0x3d372713, v52
    v_mul_f32 v53, 0x3d372713, v53
    v_mul_f32 v54, 0x3d372713, v54
    v_mul_f32 v55, 0x3d372713, v55
    v_add_f32 v52, v52, v44
    v_add_f32 v53, v53, v45
    v_add_f32 v54, v54, v46
    v_add_f32 v55, v55, v47
    v_mul_f32 v52, 0x3f4c422a, v52
    v_mul_f32 v53, 0x3f4c422a, v53
    v_mul_f32 v54, 0x3f4c422a, v54
    v_mul_f32 v55, 0x3f4c422a, v55
    v_mul_f32 v52, 0x4038aa3b, v52
    v_mul_f32 v53, 0x4038aa3b, v53
    v_mul_f32 v54, 0x4038aa3b, v54
    v_mul_f32 v55, 0x4038aa3b, v55
    v_exp_f32 v52, v52
    v_exp_f32 v53, v53
    v_exp_f32 v54, v54
    v_exp_f32 v55, v55
    v_add_f32 v52, 1.0, v52
    v_add_f32 v53, 1.0, v53
    v_add_f32 v54, 1.0, v54
    v_add_f32 v55, 1.0, v55
    v_rcp_f32 v52, v52
    v_rcp_f32 v53, v53
    v_rcp_f32 v54, v54
    v_rcp_f32 v55, v55
    v_fma_f32 v52, v52, -2.0, 1.0
    v_fma_f32 v53, v53, -2.0, 1.0
    v_fma_f32 v54, v54, -2.0, 1.0
    v_fma_f32 v55, v55, -2.0, 1.0
    v_add_f32 v52, 1.0, v52
    v_add_f32 v53, 1.0, v53
    v_add_f32 v54, 1.0, v54
    v_add_f32 v55, 1.0, v55
    v_mul_f32 v56, 0.5, v44
    v_mul_f32 v57, 0.5, v45
    v_mul_f32 v58, 0.5, v46
    v_mul_f32 v59, 0.5, v47
    v_mul_f32 v52, v56, v52
    v_mul_f32 v53, v57, v53
    v_mul_f32 v54, v58, v54
    v_mul_f32 v55, v59, v55
    v_cvt_pk_bf16_f32 v52, v52, v52
    v_cvt_pk_bf16_f32 v53, v53, v53
    v_cvt_pk_bf16_f32 v54, v54, v54
    v_cvt_pk_bf16_f32 v55, v55, v55
    v_and_b32 v52, 0xffff0000, v52
    v_and_b32 v53, 0xffff0000, v53
    v_and_b32 v54, 0xffff0000, v54
    v_and_b32 v55, 0xffff0000, v55
    v_mul_f32 v52, v52, v48
    v_mul_f32 v53, v53, v49
    v_mul_f32 v54, v54, v50
    v_mul_f32 v55, v55, v51
    v_cvt_pk_bf16_f32 v52, v52, v52
    v_cvt_pk_bf16_f32 v53, v53, v53
    v_cvt_pk_bf16_f32 v54, v54, v54
    v_cvt_pk_bf16_f32 v55, v55, v55
    v_bfe_u32 v44, v0, 4, 1
    v_lshlrev_b32 v44, 4, v44
    v_lshl_add_u32 v44, v2, 1, v44
    v_cmp_lt_u32 vcc, 31, v0
    s_and_b64 vcc, vcc, s[90:91]
    v_mov_b32 v45, 256
    v_cndmask_b32 v44, v45, v44, vcc
    ds_write_b128 v44, v[52:55] offset:512
    v_lshrrev_b32 v46, 4, v0
    v_and_b32 v47, 15, v0
    v_min_u32 v47, 5, v47
    v_lshl_add_u32 v46, v47, 2, v46
    s_mul_i32 s75, s72, 24
    v_add_u32 v46, s75, v46
    v_lshlrev_b32 v46, 2, v46
    s_waitcnt lgkmcnt(0)
    ds_read_b32 v40, v46 offset:512
    v_lshrrev_b32 v46, 4, v0
    v_lshl_add_u32 v4, v46, 10, v2
    v_lshl_add_u32 v3, v46, 14, v2
    s_waitcnt lgkmcnt(0)
    s_setprio 0
L_st:
    ds_read_b128 v[44:47], v60 offset:5120
    s_waitcnt lgkmcnt(0)
    v_cmp_ne_u32 vcc, 1, v46
    s_cmp_eq_u64 vcc, 0
    s_cbranch_scc1 L_st_ok
    s_sleep 4
    s_branch L_st
L_st_ok:
    v_mov_b32 v48, v44
    s_nop 1
    v_max_f32_dpp v48, v48, v48 quad_perm:[1,0,3,2] row_mask:0xf bank_mask:0xf
    s_nop 1
    v_max_f32_dpp v48, v48, v48 quad_perm:[2,3,0,1] row_mask:0xf bank_mask:0xf
    v_sub_f32 v49, v44, v48
    v_mul_f32 v49, 0x3fb8aa3b, v49
    v_exp_f32 v49, v49
    s_nop 0
    v_mul_f32 v50, v49, v45
    s_nop 1
    v_add_f32_dpp v50, v50, v50 quad_perm:[1,0,3,2] row_mask:0xf bank_mask:0xf
    s_nop 1
    v_add_f32_dpp v50, v50, v50 quad_perm:[2,3,0,1] row_mask:0xf bank_mask:0xf
    v_mov_b32 v52, v48
    v_mov_b32 v53, s70
    v_mov_b32 v54, v50
    v_mov_b32 v55, s70
    s_lshl_b32 s75, s68, 7
    s_lshl_b32 s77, s69, 4
    s_add_u32 s77, s77, s75
    s_add_u32 s77, s77, 1376256
    v_mov_b32 v56, 1073741824
    v_mov_b32 v57, 0
    v_cmp_eq_u32 vcc, 0, v0
    s_nop 1
    v_cndmask_b32 v56, v56, v57, vcc
    v_and_b32 v57, 7, v0
    s_add_u32 s75, s75, 1376256
    v_lshl_add_u32 v57, v57, 4, s75
    s_cmp_eq_u32 s100, 1
    s_cselect_b32 s83, 0, 2097152
    s_cbranch_scc0 L_ps_far
    buffer_store_dwordx4 v[52:55], v56, s[52:55], s77 offen
    s_branch L_ps_sent
L_ps_far:
    s_add_u32 s77, s77, 2097152
    buffer_store_dwordx4 v[52:55], v56, s[52:55], s77 offen sc1
L_ps_sent:
    s_mov_b32 s76, 200000
    buffer_load_dwordx4 v[196:199], v57, s[52:55], s83 offen sc1
L_gs:
    s_waitcnt vmcnt(0)
    v_xor_b32 v58, s70, v197
    v_xor_b32 v59, s70, v199
    v_or_b32 v58, v58, v59
    v_cmp_ne_u32 vcc, 0, v58
    s_cmp_eq_u64 vcc, 0
    s_cbranch_scc1 L_gs_ok
    s_sub_u32 s76, s76, 1
    s_cbranch_scc1 L_gs_ok
    s_sleep 8
    buffer_load_dwordx4 v[196:199], v57, s[52:55], s83 offen sc1
    s_branch L_gs
L_gs_ok:
    v_mov_b32 v48, v196
    s_nop 1
    v_max_f32_dpp v48, v48, v48 quad_perm:[1,0,3,2] row_mask:0xf bank_mask:0xf
    s_nop 1
    v_max_f32_dpp v48, v48, v48 quad_perm:[2,3,0,1] row_mask:0xf bank_mask:0xf
    s_nop 1
    v_max_f32_dpp v48, v48, v48 row_half_mirror row_mask:0xf bank_mask:0xf
    v_sub_f32 v49, v196, v48
    v_mul_f32 v49, 0x3fb8aa3b, v49
    v_exp_f32 v49, v49
    s_nop 0
    v_mul_f32 v49, v49, v198
    s_nop 1
    v_add_f32_dpp v49, v49, v49 quad_perm:[1,0,3,2] row_mask:0xf bank_mask:0xf
    s_nop 1
    v_add_f32_dpp v49, v49, v49 quad_perm:[2,3,0,1] row_mask:0xf bank_mask:0xf
    s_nop 1
    v_add_f32_dpp v49, v49, v49 row_half_mirror row_mask:0xf bank_mask:0xf
    v_rcp_f32 v49, v49
    v_sub_f32 v50, v44, v48
    v_mul_f32 v50, 0x3fb8aa3b, v50
    v_exp_f32 v50, v50
    s_nop 0
    v_mul_f32 v50, v50, v49
    s_nop 0
    v_readlane_b32 s92, v50, 0
    v_readlane_b32 s93, v50, 1
    v_readlane_b32 s94, v50, 2
    v_readlane_b32 s95, v50, 3
L_skip_s:
    s_setprio 3
    s_barrier
    s_mov_b32 s75, 0
    buffer_load_dwordx4 v[128:131], v4, s[48:51], s75 offen nt
    s_mov_b32 s75, 4096
    buffer_load_dwordx4 v[132:135], v4, s[48:51], s75 offen nt
    s_mov_b32 s75, 8192
    buffer_load_dwordx4 v[136:139], v4, s[48:51], s75 offen nt
    s_mov_b32 s75, 12288
    buffer_load_dwordx4 v[140:143], v4, s[48:51], s75 offen nt
    s_mov_b32 s75, 16384
    buffer_load_dwordx4 v[144:147], v4, s[48:51], s75 offen nt
    s_mov_b32 s75, 20480
    buffer_load_dwordx4 v[148:151], v4, s[48:51], s75 offen nt
    s_mov_b32 s75, 0
    buffer_load_dwordx4 v[64:67], v3, s[44:47], s75 offen offset:0 nt
    buffer_load_dwordx4 v[68:71], v3, s[44:47], s75 offen offset:1024 nt
    buffer_load_dwordx4 v[72:75], v3, s[44:47], s75 offen offset:2048 nt
    buffer_load_dwordx4 v[76:79], v3, s[44:47], s75 offen offset:3072 nt
    s_mov_b32 s75, 4096
    buffer_load_dwordx4 v[80:83], v3, s[44:47], s75 offen offset:0 nt
    buffer_load_dwordx4 v[84:87], v3, s[44:47], s75 offen offset:1024 nt
    buffer_load_dwordx4 v[88:91], v3, s[44:47], s75 offen offset:2048 nt
    buffer_load_dwordx4 v[92:95], v3, s[44:47], s75 offen offset:3072 nt
    s_mov_b32 s75, 8192
    buffer_load_dwordx4 v[96:99], v3, s[44:47], s75 offen offset:0 nt
    buffer_load_dwordx4 v[100:103], v3, s[44:47], s75 offen offset:1024 nt
    buffer_load_dwordx4 v[104:107], v3, s[44:47], s75 offen offset:2048 nt
    buffer_load_dwordx4 v[108:111], v3, s[44:47], s75 offen offset:3072 nt
    s_mov_b32 s75, 12288
    buffer_load_dwordx4 v[112:115], v3, s[44:47], s75 offen offset:0 nt
    buffer_load_dwordx4 v[116:119], v3, s[44:47], s75 offen offset:1024 nt
    buffer_load_dwordx4 v[120:123], v3, s[44:47], s75 offen offset:2048 nt
    buffer_load_dwordx4 v[124:127], v3, s[44:47], s75 offen offset:3072 nt
    s_lshl_b32 s75, s71, 8
    s_lshl_b32 s76, s68, 3
    s_add_u32 s75, s75, s76
    s_lshl_b32 s76, s72, 2
    s_add_u32 s80, s75, s76
    s_load_dword s81, s[4:5], s80
    s_lshl_b32 s82, s71, 16
    s_lshl_b32 s76, s68, 11
    s_add_u32 s82, s82, s76
    s_lshl_b32 s76, s72, 10
    s_add_u32 s82, s82, s76
    s_add_u32 s82, s82, 1114112
    v_bfe_u32 v52, v0, 4, 1
    v_lshrrev_b32 v53, 5, v0
    v_lshl_add_u32 v52, v52, 1, v53
    v_lshlrev_b32 v52, 4, v52
    v_lshl_add_u32 v216, v2, 2, v52
    s_lshl_b32 s75, s71, 16
    s_lshl_b32 s76, s68, 5
    s_add_u32 s75, s75, s76
    s_lshl_b32 s76, s72, 4
    s_add_u32 s75, s75, s76
    s_add_u32 s75, s75, 1114112
    v_lshl_add_u32 v217, v0, 10, s75
    v_mov_b32 v59, 0
    v_mov_b32 v58, 1073741824
    v_cmp_eq_u32 vcc, 0, v0
    s_nop 1
    v_cndmask_b32 v58, v58, v59, vcc
    s_lshl_b32 s77, s68, 3
    s_add_u32 s77, s77, s69
    s_lshl_b32 s77, s77, 11
    s_add_u32 s77, s77, 589824
    s_waitcnt lgkmcnt(0)
    s_lshl_b32 s75, s81, 16
    v_mov_b32 v218, s75
    s_and_b32 s75, s81, 0xffff0000
    v_mov_b32 v219, s75
    v_mov_b32 v220, s80
    v_mov_b32 v221, 1073741824
    v_cndmask_b32 v220, v221, v220, vcc
    s_barrier
    ds_read_b64 v[160:161], v61 offset:1024
    ds_read_b64 v[162:163], v61 offset:2048
    ds_read_b64 v[164:165], v61 offset:3072
    ds_read_b64 v[166:167], v61 offset:4096
    v_mov_b32 v49, s70
    v_mov_b32 v51, s70
    s_waitcnt lgkmcnt(0)
    v_mul_f32 v48, s92, v160
    v_mul_f32 v50, s92, v161
    v_fmac_f32 v48, s93, v162
    v_fmac_f32 v50, s93, v163
    v_fmac_f32 v48, s94, v164
    v_fmac_f32 v50, s94, v165
    v_fmac_f32 v48, s95, v166
    v_fmac_f32 v50, s95, v167
    s_cmp_eq_u32 s100, 1
    s_cselect_b32 s83, 0, 2097152
    s_cbranch_scc0 L_p1_far
    buffer_store_dwordx4 v[48:51], v1, s[52:55], s77 offen
    s_branch L_p1_sent
L_p1_far:
    s_add_u32 s77, s77, 2097152
    buffer_store_dwordx4 v[48:51], v1, s[52:55], s77 offen sc1
L_p1_sent:
    s_mov_b32 s76, 200000
    s_add_u32 s75, s83, 0
    buffer_load_dwordx2 v[176:177], v42, s[52:55], s75 offen offset:0 sc1
    buffer_load_dwordx2 v[178:179], v42, s[52:55], s75 offen offset:2048 sc1
    s_add_u32 s75, s83, 4096
    buffer_load_dwordx2 v[180:181], v42, s[52:55], s75 offen offset:0 sc1
    buffer_load_dwordx2 v[182:183], v42, s[52:55], s75 offen offset:2048 sc1
    s_add_u32 s75, s83, 8192
    buffer_load_dwordx2 v[184:185], v42, s[52:55], s75 offen offset:0 sc1
    buffer_load_dwordx2 v[186:187], v42, s[52:55], s75 offen offset:2048 sc1
    s_add_u32 s75, s83, 12288
    buffer_load_dwordx2 v[188:189], v42, s[52:55], s75 offen offset:0 sc1
    buffer_load_dwordx2 v[190:191], v42, s[52:55], s75 offen offset:2048 sc1
    v_and_b32_dpp v16, v40, v8 row_newbcast:0 row_mask:0xf bank_mask:0xf
    v_and_b32_dpp v17, v40, v9 row_newbcast:0 row_mask:0xf bank_mask:0xf
    v_and_b32_dpp v18, v40, v10 row_newbcast:0 row_mask:0xf bank_mask:0xf
    v_and_b32_dpp v19, v40, v11 row_newbcast:0 row_mask:0xf bank_mask:0xf
    v_and_b32_dpp v20, v40, v8 row_newbcast:1 row_mask:0xf bank_mask:0xf
    v_and_b32_dpp v21, v40, v9 row_newbcast:1 row_mask:0xf bank_mask:0xf
    v_and_b32_dpp v22, v40, v10 row_newbcast:1 row_mask:0xf bank_mask:0xf
    v_and_b32_dpp v23, v40, v11 row_newbcast:1 row_mask:0xf bank_mask:0xf
    s_waitcnt vmcnt(29)
    v_mfma_f32_16x16x32_bf16 v[192:195], v[16:19], v[128:131], 0
    v_and_b32_dpp v16, v40, v8 row_newbcast:2 row_mask:0xf bank_mask:0xf
    v_and_b32_dpp v17, v40, v9 row_newbcast:2 row_mask:0xf bank_mask:0xf
    v_and_b32_dpp v18, v40, v10 row_newbcast:2 row_mask:0xf bank_mask:0xf
    v_and_b32_dpp v19, v40, v11 row_newbcast:2 row_mask:0xf bank_mask:0xf
    s_waitcnt vmcnt(28)
    v_mfma_f32_16x16x32_bf16 v[192:195], v[20:23], v[132:135], v[192:195]
    v_and_b32_dpp v20, v40, v8 row_newbcast:3 row_mask:0xf bank_mask:0xf
    v_and_b32_dpp v21, v40, v9 row_newbcast:3 row_mask:0xf bank_mask:0xf
    v_and_b32_dpp v22, v40, v10 row_newbcast:3 row_mask:0xf bank_mask:0xf
    v_and_b32_dpp v23, v40, v11 row_newbcast:3 row_mask:0xf bank_mask:0xf
    s_waitcnt vmcnt(27)
    v_mfma_f32_16x16x32_bf16 v[192:195], v[16:19], v[136:139], v[192:195]
    v_and_b32_dpp v16, v40, v8 row_newbcast:4 row_mask:0xf bank_mask:0xf
    v_and_b32_dpp v17, v40, v9 row_newbcast:4 row_mask:0xf bank_mask:0xf
    v_and_b32_dpp v18, v40, v10 row_newbcast:4 row_mask:0xf bank_mask:0xf
    v_and_b32_dpp v19, v40, v11 row_newbcast:4 row_mask:0xf bank_mask:0xf
    s_waitcnt vmcnt(26)
    v_mfma_f32_16x16x32_bf16 v[192:195], v[20:23], v[140:143], v[192:195]
    v_and_b32_dpp v20, v40, v8 row_newbcast:5 row_mask:0xf bank_mask:0xf
    v_and_b32_dpp v21, v40, v9 row_newbcast:5 row_mask:0xf bank_mask:0xf
    v_and_b32_dpp v22, v40, v10 row_newbcast:5 row_mask:0xf bank_mask:0xf
    v_and_b32_dpp v23, v40, v11 row_newbcast:5 row_mask:0xf bank_mask:0xf
    s_waitcnt vmcnt(25)
    v_mfma_f32_16x16x32_bf16 v[192:195], v[16:19], v[144:147], v[192:195]
    s_waitcnt vmcnt(24)
    v_mfma_f32_16x16x32_bf16 v[192:195], v[20:23], v[148:151], v[192:195]
L_g1:
    s_add_u32 s75, s83, 0
    buffer_load_dwordx2 v[224:225], v42, s[52:55], s75 offen offset:0 sc1
    buffer_load_dwordx2 v[226:227], v42, s[52:55], s75 offen offset:2048 sc1
    s_add_u32 s75, s83, 4096
    buffer_load_dwordx2 v[228:229], v42, s[52:55], s75 offen offset:0 sc1
    buffer_load_dwordx2 v[230:231], v42, s[52:55], s75 offen offset:2048 sc1
    s_add_u32 s75, s83, 8192
    buffer_load_dwordx2 v[232:233], v42, s[52:55], s75 offen offset:0 sc1
    buffer_load_dwordx2 v[234:235], v42, s[52:55], s75 offen offset:2048 sc1
    s_add_u32 s75, s83, 12288
    buffer_load_dwordx2 v[236:237], v42, s[52:55], s75 offen offset:0 sc1
    buffer_load_dwordx2 v[238:239], v42, s[52:55], s75 offen offset:2048 sc1
    s_waitcnt vmcnt(8)
    v_min3_u32 v44, v177, v179, v181
    v_max3_u32 v45, v177, v179, v181
    v_min3_u32 v44, v44, v183, v185
    v_max3_u32 v45, v45, v183, v185
    v_min3_u32 v44, v44, v187, v189
    v_max3_u32 v45, v45, v187, v189
    v_min_u32 v44, v44, v191
    v_max_u32 v45, v45, v191
    v_cmp_ne_u32 vcc, s70, v44
    v_cmp_ne_u32 s[84:85], s70, v45
    s_or_b64 vcc, vcc, s[84:85]
    s_cmp_eq_u64 vcc, 0
    s_cbranch_scc1 L_g1_ok0
    s_add_u32 s75, s83, 0
    buffer_load_dwordx2 v[176:177], v42, s[52:55], s75 offen offset:0 sc1
    buffer_load_dwordx2 v[178:179], v42, s[52:55], s75 offen offset:2048 sc1
    s_add_u32 s75, s83, 4096
    buffer_load_dwordx2 v[180:181], v42, s[52:55], s75 offen offset:0 sc1
    buffer_load_dwordx2 v[182:183], v42, s[52:55], s75 offen offset:2048 sc1
    s_add_u32 s75, s83, 8192
    buffer_load_dwordx2 v[184:185], v42, s[52:55], s75 offen offset:0 sc1
    buffer_load_dwordx2 v[186:187], v42, s[52:55], s75 offen offset:2048 sc1
    s_add_u32 s75, s83, 12288
    buffer_load_dwordx2 v[188:189], v42, s[52:55], s75 offen offset:0 sc1
    buffer_load_dwordx2 v[190:191], v42, s[52:55], s75 offen offset:2048 sc1
    s_waitcnt vmcnt(8)
    v_min3_u32 v44, v225, v227, v229
    v_max3_u32 v45, v225, v227, v229
    v_min3_u32 v44, v44, v231, v233
    v_max3_u32 v45, v45, v231, v233
    v_min3_u32 v44, v44, v235, v237
    v_max3_u32 v45, v45, v235, v237
    v_min_u32 v44, v44, v239
    v_max_u32 v45, v45, v239
    v_cmp_ne_u32 vcc, s70, v44
    v_cmp_ne_u32 s[84:85], s70, v45
    s_or_b64 vcc, vcc, s[84:85]
    s_cmp_eq_u64 vcc, 0
    s_cbranch_scc1 L_g1_ok1
    s_sub_u32 s76, s76, 1
    s_cbranch_scc0 L_g1
L_g1_ok0:
    v_add_f32 v46, v176, v178
    v_add_f32 v47, v180, v182
    v_add_f32 v48, v184, v186
    v_add_f32 v49, v188, v190
    v_add_f32 v46, v46, v47
    v_add_f32 v48, v48, v49
    v_add_f32 v46, v46, v48
    s_branch L_g1_done
L_g1_ok1:
    v_add_f32 v46, v224, v226
    v_add_f32 v47, v228, v230
    v_add_f32 v48, v232, v234
    v_add_f32 v49, v236, v238
    v_add_f32 v46, v46, v47
    v_add_f32 v48, v48, v49
    v_add_f32 v46, v46, v48
L_g1_done:
    v_cvt_pk_bf16_f32 v40, v46, v46
    s_nop 1
    v_and_b32_dpp v16, v40, v8 row_newbcast:0 row_mask:0xf bank_mask:0xf
    v_and_b32_dpp v17, v40, v9 row_newbcast:0 row_mask:0xf bank_mask:0xf
    v_and_b32_dpp v18, v40, v10 row_newbcast:0 row_mask:0xf bank_mask:0xf
    v_and_b32_dpp v19, v40, v11 row_newbcast:0 row_mask:0xf bank_mask:0xf
    v_and_b32_dpp v20, v40, v8 row_newbcast:1 row_mask:0xf bank_mask:0xf
    v_and_b32_dpp v21, v40, v9 row_newbcast:1 row_mask:0xf bank_mask:0xf
    v_and_b32_dpp v22, v40, v10 row_newbcast:1 row_mask:0xf bank_mask:0xf
    v_and_b32_dpp v23, v40, v11 row_newbcast:1 row_mask:0xf bank_mask:0xf
    v_mfma_f32_16x16x32_bf16 v[192:195], v[16:19], v[64:67], v[192:195]
    v_and_b32_dpp v16, v40, v8 row_newbcast:2 row_mask:0xf bank_mask:0xf
    v_and_b32_dpp v17, v40, v9 row_newbcast:2 row_mask:0xf bank_mask:0xf
    v_and_b32_dpp v18, v40, v10 row_newbcast:2 row_mask:0xf bank_mask:0xf
    v_and_b32_dpp v19, v40, v11 row_newbcast:2 row_mask:0xf bank_mask:0xf
    v_mfma_f32_16x16x32_bf16 v[192:195], v[20:23], v[68:71], v[192:195]
    v_and_b32_dpp v20, v40, v8 row_newbcast:3 row_mask:0xf bank_mask:0xf
    v_and_b32_dpp v21, v40, v9 row_newbcast:3 row_mask:0xf bank_mask:0xf
    v_and_b32_dpp v22, v40, v10 row_newbcast:3 row_mask:0xf bank_mask:0xf
    v_and_b32_dpp v23, v40, v11 row_newbcast:3 row_mask:0xf bank_mask:0xf
    v_mfma_f32_16x16x32_bf16 v[192:195], v[16:19], v[72:75], v[192:195]
    v_and_b32_dpp v16, v40, v8 row_newbcast:4 row_mask:0xf bank_mask:0xf
    v_and_b32_dpp v17, v40, v9 row_newbcast:4 row_mask:0xf bank_mask:0xf
    v_and_b32_dpp v18, v40, v10 row_newbcast:4 row_mask:0xf bank_mask:0xf
    v_and_b32_dpp v19, v40, v11 row_newbcast:4 row_mask:0xf bank_mask:0xf
    v_mfma_f32_16x16x32_bf16 v[192:195], v[20:23], v[76:79], v[192:195]
    v_and_b32_dpp v20, v40, v8 row_newbcast:5 row_mask:0xf bank_mask:0xf
    v_and_b32_dpp v21, v40, v9 row_newbcast:5 row_mask:0xf bank_mask:0xf
    v_and_b32_dpp v22, v40, v10 row_newbcast:5 row_mask:0xf bank_mask:0xf
    v_and_b32_dpp v23, v40, v11 row_newbcast:5 row_mask:0xf bank_mask:0xf
    v_mfma_f32_16x16x32_bf16 v[192:195], v[16:19], v[80:83], v[192:195]
    v_and_b32_dpp v16, v40, v8 row_newbcast:6 row_mask:0xf bank_mask:0xf
    v_and_b32_dpp v17, v40, v9 row_newbcast:6 row_mask:0xf bank_mask:0xf
    v_and_b32_dpp v18, v40, v10 row_newbcast:6 row_mask:0xf bank_mask:0xf
    v_and_b32_dpp v19, v40, v11 row_newbcast:6 row_mask:0xf bank_mask:0xf
    v_mfma_f32_16x16x32_bf16 v[192:195], v[20:23], v[84:87], v[192:195]
    v_and_b32_dpp v20, v40, v8 row_newbcast:7 row_mask:0xf bank_mask:0xf
    v_and_b32_dpp v21, v40, v9 row_newbcast:7 row_mask:0xf bank_mask:0xf
    v_and_b32_dpp v22, v40, v10 row_newbcast:7 row_mask:0xf bank_mask:0xf
    v_and_b32_dpp v23, v40, v11 row_newbcast:7 row_mask:0xf bank_mask:0xf
    v_mfma_f32_16x16x32_bf16 v[192:195], v[16:19], v[88:91], v[192:195]
    v_and_b32_dpp v16, v40, v8 row_newbcast:8 row_mask:0xf bank_mask:0xf
    v_and_b32_dpp v17, v40, v9 row_newbcast:8 row_mask:0xf bank_mask:0xf
    v_and_b32_dpp v18, v40, v10 row_newbcast:8 row_mask:0xf bank_mask:0xf
    v_and_b32_dpp v19, v40, v11 row_newbcast:8 row_mask:0xf bank_mask:0xf
    v_mfma_f32_16x16x32_bf16 v[192:195], v[20:23], v[92:95], v[192:195]
    v_and_b32_dpp v20, v40, v8 row_newbcast:9 row_mask:0xf bank_mask:0xf
    v_and_b32_dpp v21, v40, v9 row_newbcast:9 row_mask:0xf bank_mask:0xf
    v_and_b32_dpp v22, v40, v10 row_newbcast:9 row_mask:0xf bank_mask:0xf
    v_and_b32_dpp v23, v40, v11 row_newbcast:9 row_mask:0xf bank_mask:0xf
    v_mfma_f32_16x16x32_bf16 v[192:195], v[16:19], v[96:99], v[192:195]
    v_and_b32_dpp v16, v40, v8 row_newbcast:10 row_mask:0xf bank_mask:0xf
    v_and_b32_dpp v17, v40, v9 row_newbcast:10 row_mask:0xf bank_mask:0xf
    v_and_b32_dpp v18, v40, v10 row_newbcast:10 row_mask:0xf bank_mask:0xf
    v_and_b32_dpp v19, v40, v11 row_newbcast:10 row_mask:0xf bank_mask:0xf
    v_mfma_f32_16x16x32_bf16 v[192:195], v[20:23], v[100:103], v[192:195]
    v_and_b32_dpp v20, v40, v8 row_newbcast:11 row_mask:0xf bank_mask:0xf
    v_and_b32_dpp v21, v40, v9 row_newbcast:11 row_mask:0xf bank_mask:0xf
    v_and_b32_dpp v22, v40, v10 row_newbcast:11 row_mask:0xf bank_mask:0xf
    v_and_b32_dpp v23, v40, v11 row_newbcast:11 row_mask:0xf bank_mask:0xf
    v_mfma_f32_16x16x32_bf16 v[192:195], v[16:19], v[104:107], v[192:195]
    v_and_b32_dpp v16, v40, v8 row_newbcast:12 row_mask:0xf bank_mask:0xf
    v_and_b32_dpp v17, v40, v9 row_newbcast:12 row_mask:0xf bank_mask:0xf
    v_and_b32_dpp v18, v40, v10 row_newbcast:12 row_mask:0xf bank_mask:0xf
    v_and_b32_dpp v19, v40, v11 row_newbcast:12 row_mask:0xf bank_mask:0xf
    v_mfma_f32_16x16x32_bf16 v[192:195], v[20:23], v[108:111], v[192:195]
    v_and_b32_dpp v20, v40, v8 row_newbcast:13 row_mask:0xf bank_mask:0xf
    v_and_b32_dpp v21, v40, v9 row_newbcast:13 row_mask:0xf bank_mask:0xf
    v_and_b32_dpp v22, v40, v10 row_newbcast:13 row_mask:0xf bank_mask:0xf
    v_and_b32_dpp v23, v40, v11 row_newbcast:13 row_mask:0xf bank_mask:0xf
    v_mfma_f32_16x16x32_bf16 v[192:195], v[16:19], v[112:115], v[192:195]
    v_and_b32_dpp v16, v40, v8 row_newbcast:14 row_mask:0xf bank_mask:0xf
    v_and_b32_dpp v17, v40, v9 row_newbcast:14 row_mask:0xf bank_mask:0xf
    v_and_b32_dpp v18, v40, v10 row_newbcast:14 row_mask:0xf bank_mask:0xf
    v_and_b32_dpp v19, v40, v11 row_newbcast:14 row_mask:0xf bank_mask:0xf
    v_mfma_f32_16x16x32_bf16 v[192:195], v[20:23], v[116:119], v[192:195]
    v_and_b32_dpp v20, v40, v8 row_newbcast:15 row_mask:0xf bank_mask:0xf
    v_and_b32_dpp v21, v40, v9 row_newbcast:15 row_mask:0xf bank_mask:0xf
    v_and_b32_dpp v22, v40, v10 row_newbcast:15 row_mask:0xf bank_mask:0xf
    v_and_b32_dpp v23, v40, v11 row_newbcast:15 row_mask:0xf bank_mask:0xf
    v_mfma_f32_16x16x32_bf16 v[192:195], v[16:19], v[120:123], v[192:195]
    s_nop 0
    v_mfma_f32_16x16x32_bf16 v[192:195], v[20:23], v[124:127], v[192:195]
    s_nop 7
    v_mov_b32 v44, v192
    v_mov_b32 v46, v193
    v_mov_b32 v48, v194
    v_mov_b32 v49, v195
    v_mov_b32 v45, s70
    v_mov_b32 v47, s70
    v_permlane32_swap_b32 v44, v48
    v_permlane32_swap_b32 v46, v49
    buffer_store_dwordx4 v[44:47], v216, s[52:55], s82 offen sc1
    s_mov_b32 s76, 200000
    buffer_load_dwordx4 v[176:179], v217, s[52:55], 0 offen sc1
L_g2:
    buffer_load_dwordx4 v[180:183], v217, s[52:55], 0 offen sc1
    s_waitcnt vmcnt(1)
    v_xor_b32 v55, s70, v177
    v_xor_b32 v56, s70, v179
    v_or_b32 v55, v55, v56
    v_cmp_ne_u32 vcc, 0, v55
    s_cmp_eq_u64 vcc, 0
    s_cbranch_scc1 L_g2_ok0
    buffer_load_dwordx4 v[176:179], v217, s[52:55], 0 offen sc1
    s_waitcnt vmcnt(1)
    v_xor_b32 v55, s70, v181
    v_xor_b32 v56, s70, v183
    v_or_b32 v55, v55, v56
    v_cmp_ne_u32 vcc, 0, v55
    s_cmp_eq_u64 vcc, 0
    s_cbranch_scc1 L_g2_ok1
    s_sub_u32 s76, s76, 1
    s_cbranch_scc0 L_g2
L_g2_ok0:
    v_mov_b32 v196, v176
    v_mov_b32 v198, v178
    s_branch L_g2_done
L_g2_ok1:
    v_mov_b32 v196, v180
    v_mov_b32 v198, v182
L_g2_done:
    s_nop 0
    v_add_f32_dpp v196, v196, v196 row_mirror row_mask:0xf bank_mask:0xf
    v_add_f32_dpp v198, v198, v198 row_mirror row_mask:0xf bank_mask:0xf
    s_nop 0
    v_add_f32_dpp v196, v196, v196 row_half_mirror row_mask:0xf bank_mask:0xf
    v_add_f32_dpp v198, v198, v198 row_half_mirror row_mask:0xf bank_mask:0xf
    s_nop 0
    v_add_f32_dpp v196, v196, v196 quad_perm:[2,3,0,1] row_mask:0xf bank_mask:0xf
    v_add_f32_dpp v198, v198, v198 quad_perm:[2,3,0,1] row_mask:0xf bank_mask:0xf
    s_nop 0
    v_add_f32_dpp v196, v196, v196 quad_perm:[1,0,3,2] row_mask:0xf bank_mask:0xf
    v_add_f32_dpp v198, v198, v198 quad_perm:[1,0,3,2] row_mask:0xf bank_mask:0xf
    s_nop 0
    v_add_f32_dpp v196, v196, v196 row_bcast:15 row_mask:0xa bank_mask:0xf
    v_add_f32_dpp v198, v198, v198 row_bcast:15 row_mask:0xa bank_mask:0xf
    s_nop 0
    v_add_f32_dpp v196, v196, v196 row_bcast:31 row_mask:0xc bank_mask:0xf
    v_add_f32_dpp v198, v198, v198 row_bcast:31 row_mask:0xc bank_mask:0xf
    v_readlane_b32 s78, v196, 63
    v_readlane_b32 s79, v198, 63
    s_nop 0
    v_add_f32 v44, s78, v218
    v_add_f32 v45, s79, v219
    v_cvt_pk_bf16_f32 v44, v44, v45
    buffer_store_dword v44, v220, s[56:59], 0 offen
    s_cmp_lg_u32 s2, 0
    s_cbranch_scc1 L_fin
    v_mov_b32 v48, s70
    v_mov_b32 v49, 0
    v_mov_b32 v46, 1073741824
    v_cmp_eq_u32 vcc, 0, v0
    s_nop 1
    v_cndmask_b32 v49, v46, v49, vcc
    buffer_store_dword v48, v49, s[52:55], 0 offen sc1
L_fin:
L_done:
    s_endpgm
L_stream:
    s_add_u32 s36, s8, s74
    s_addc_u32 s37, s9, 0
    s_mov_b32 s38, 0x40000
    s_mov_b32 s39, 0x20000
    v_and_b32 v2, 15, v0
    v_lshlrev_b32 v2, 4, v2
    v_and_b32 v44, 2, v0
    v_cmp_eq_u32 s[86:87], 2, v44
    v_and_b32 v44, 1, v0
    v_cmp_eq_u32 s[88:89], 1, v44
    v_and_b32 v44, 1, v0
    v_cmp_eq_u32 vcc, 1, v44
    v_mov_b32 v45, 0xffff
    v_mov_b32 v46, 0xffff0000
    v_cndmask_b32 v45, v45, v46, vcc
    v_bfe_u32 v46, v0, 1, 3
    v_cmp_eq_u32 vcc, 0, v46
    s_nop 1
    v_cndmask_b32 v8, 0, v45, vcc
    v_cmp_eq_u32 vcc, 1, v46
    s_nop 1
    v_cndmask_b32 v9, 0, v45, vcc
    v_cmp_eq_u32 vcc, 2, v46
    s_nop 1
    v_cndmask_b32 v10, 0, v45, vcc
    v_cmp_eq_u32 vcc, 3, v46
    s_nop 1
    v_cndmask_b32 v11, 0, v45, vcc
    s_waitcnt vmcnt(1)
    buffer_load_dwordx4 v[72:75], v1, s[32:35], s76 offen nt
    s_addk_i32 s76, 0x1000
    buffer_load_dwordx4 v[76:79], v1, s[32:35], s76 offen nt
    s_addk_i32 s76, 0x1000
    buffer_load_dwordx4 v[80:83], v1, s[32:35], s76 offen nt
    s_addk_i32 s76, 0x1000
    buffer_load_dwordx4 v[84:87], v1, s[32:35], s76 offen nt
    s_addk_i32 s76, 0x1000
    buffer_load_dwordx4 v[88:91], v1, s[32:35], s76 offen nt
    s_addk_i32 s76, 0x1000
    s_waitcnt vmcnt(5)
    buffer_load_dwordx4 v[92:95], v1, s[32:35], s76 offen nt
    s_addk_i32 s76, 0x1000
    s_waitcnt vmcnt(5)
    buffer_load_dwordx4 v[96:99], v1, s[32:35], s76 offen nt
    s_addk_i32 s76, 0x1000
    s_waitcnt vmcnt(5)
    buffer_load_dwordx4 v[100:103], v1, s[32:35], s76 offen nt
    s_addk_i32 s76, 0x1000
    s_waitcnt vmcnt(5)
    buffer_load_dwordx4 v[104:107], v1, s[32:35], s76 offen nt
    s_addk_i32 s76, 0x1000
    s_waitcnt vmcnt(5)
    buffer_load_dwordx4 v[108:111], v1, s[32:35], s76 offen nt
    s_addk_i32 s76, 0x1000
    s_waitcnt vmcnt(5)
    buffer_load_dwordx4 v[112:115], v1, s[32:35], s76 offen nt
    s_addk_i32 s76, 0x1000
    s_waitcnt vmcnt(5)
    buffer_load_dwordx4 v[116:119], v1, s[32:35], s76 offen nt
    s_addk_i32 s76, 0x1000
    s_waitcnt vmcnt(5)
    buffer_load_dwordx4 v[120:123], v1, s[32:35], s76 offen nt
    s_addk_i32 s76, 0x1000
    s_waitcnt vmcnt(5)
    buffer_load_dwordx4 v[124:127], v1, s[32:35], s76 offen nt
    s_addk_i32 s76, 0x1000
    s_waitcnt vmcnt(5)
    buffer_load_dwordx4 v[128:131], v1, s[32:35], s76 offen nt
    s_addk_i32 s76, 0x1000
    s_waitcnt vmcnt(5)
    buffer_load_dwordx4 v[132:135], v1, s[32:35], s76 offen nt
    s_addk_i32 s76, 0x1000
    s_waitcnt vmcnt(5)
    buffer_load_dwordx4 v[136:139], v1, s[32:35], s76 offen nt
    s_addk_i32 s76, 0x1000
    s_waitcnt vmcnt(5)
    buffer_load_dwordx4 v[140:143], v1, s[32:35], s76 offen nt
    s_addk_i32 s76, 0x1000
    s_waitcnt vmcnt(5)
    buffer_load_dwordx4 v[144:147], v1, s[32:35], s76 offen nt
    s_addk_i32 s76, 0x1000
    s_waitcnt vmcnt(5)
    buffer_load_dwordx4 v[148:151], v1, s[32:35], s76 offen nt
    s_addk_i32 s76, 0x1000
    s_waitcnt vmcnt(5)
    buffer_load_dwordx4 v[152:155], v1, s[32:35], s76 offen nt
    s_addk_i32 s76, 0x1000
    s_waitcnt vmcnt(5)
    buffer_load_dwordx4 v[156:159], v1, s[32:35], s76 offen nt
    s_addk_i32 s76, 0x1000
    s_waitcnt vmcnt(5)
    buffer_load_dwordx4 v[160:163], v1, s[32:35], s76 offen nt
    s_addk_i32 s76, 0x1000
    s_waitcnt vmcnt(5)
    buffer_load_dwordx4 v[164:167], v1, s[32:35], s76 offen nt
    s_addk_i32 s76, 0x1000
    s_waitcnt vmcnt(5)
    buffer_load_dwordx4 v[168:171], v1, s[32:35], s76 offen nt
    s_addk_i32 s76, 0x1000
    s_waitcnt vmcnt(5)
    buffer_load_dwordx4 v[172:175], v1, s[32:35], s76 offen nt
    s_addk_i32 s76, 0x1000
    s_waitcnt vmcnt(5)
    buffer_load_dwordx4 v[176:179], v1, s[32:35], s76 offen nt
    s_addk_i32 s76, 0x1000
    s_waitcnt vmcnt(5)
    buffer_load_dwordx4 v[180:183], v1, s[32:35], s76 offen nt
    s_addk_i32 s76, 0x1000
    s_waitcnt vmcnt(5)
    buffer_load_dwordx4 v[184:187], v1, s[32:35], s76 offen nt
    s_addk_i32 s76, 0x1000
    s_waitcnt vmcnt(5)
    buffer_load_dwordx4 v[188:191], v1, s[32:35], s76 offen nt
    s_addk_i32 s76, 0x1000
    s_waitcnt vmcnt(5)
    buffer_load_dwordx4 v[192:195], v1, s[32:35], s76 offen nt
    s_addk_i32 s76, 0x1000
    s_waitcnt vmcnt(5)
    buffer_load_dwordx4 v[196:199], v1, s[32:35], s76 offen nt
    s_addk_i32 s76, 0x1000
    s_waitcnt vmcnt(5)
    buffer_load_dwordx4 v[200:203], v1, s[32:35], s76 offen nt
    s_addk_i32 s76, 0x1000
    s_waitcnt vmcnt(5)
    buffer_load_dwordx4 v[204:207], v1, s[32:35], s76 offen nt
    s_addk_i32 s76, 0x1000
    s_waitcnt vmcnt(5)
    buffer_load_dwordx4 v[208:211], v1, s[32:35], s76 offen nt
    s_addk_i32 s76, 0x1000
    s_waitcnt vmcnt(5)
    buffer_load_dwordx4 v[212:215], v1, s[32:35], s76 offen nt
    s_addk_i32 s76, 0x1000
    s_waitcnt vmcnt(5)
    buffer_load_dwordx4 v[216:219], v1, s[32:35], s76 offen nt
    s_addk_i32 s76, 0x1000
    s_waitcnt vmcnt(5)
    buffer_load_dwordx4 v[220:223], v1, s[32:35], s76 offen nt
    s_addk_i32 s76, 0x1000
    s_waitcnt vmcnt(5)
    buffer_load_dwordx4 v[224:227], v1, s[32:35], s76 offen nt
    s_addk_i32 s76, 0x1000
    s_waitcnt vmcnt(5)
    buffer_load_dwordx4 v[228:231], v1, s[32:35], s76 offen nt
    s_addk_i32 s76, 0x1000
    s_waitcnt vmcnt(5)
    buffer_load_dwordx4 v[232:235], v1, s[32:35], s76 offen nt
    s_addk_i32 s76, 0x1000
    s_waitcnt vmcnt(5)
    buffer_load_dwordx4 v[236:239], v1, s[32:35], s76 offen nt
    s_addk_i32 s76, 0x1000
    s_waitcnt vmcnt(5)
    buffer_load_dwordx4 v[240:243], v1, s[32:35], s76 offen nt
    s_addk_i32 s76, 0x1000
    s_waitcnt vmcnt(5)
    buffer_load_dwordx4 v[244:247], v1, s[32:35], s76 offen nt
    s_addk_i32 s76, 0x1000
    s_waitcnt vmcnt(5)
    buffer_load_dwordx4 v[248:251], v1, s[32:35], s76 offen nt
    s_addk_i32 s76, 0x1000
    s_waitcnt vmcnt(5)
    buffer_load_dwordx4 v[252:255], v1, s[32:35], s76 offen nt
    s_addk_i32 s76, 0x1000
    s_barrier
    ds_read_b128 v[4:7], v2 offset:0
    s_waitcnt lgkmcnt(0)
    v_dot2_f32_bf16 v28, v64, v4, 0
    v_dot2_f32_bf16 v29, v68, v4, 0
    v_dot2_f32_bf16 v30, v72, v4, 0
    v_dot2_f32_bf16 v31, v76, v4, 0
    v_dot2_f32_bf16 v28, v65, v5, v28
    v_dot2_f32_bf16 v29, v69, v5, v29
    v_dot2_f32_bf16 v30, v73, v5, v30
    v_dot2_f32_bf16 v31, v77, v5, v31
    v_dot2_f32_bf16 v28, v66, v6, v28
    v_dot2_f32_bf16 v29, v70, v6, v29
    v_dot2_f32_bf16 v30, v74, v6, v30
    v_dot2_f32_bf16 v31, v78, v6, v31
    v_dot2_f32_bf16 v28, v67, v7, v28
    v_dot2_f32_bf16 v29, v71, v7, v29
    v_dot2_f32_bf16 v30, v75, v7, v30
    v_dot2_f32_bf16 v31, v79, v7, v31
    s_waitcnt vmcnt(4)
    buffer_load_dwordx4 v[64:67], v1, s[32:35], s76 offen nt
    s_addk_i32 s76, 0x1000
    v_dot2_f32_bf16 v32, v80, v4, 0
    v_dot2_f32_bf16 v33, v84, v4, 0
    v_dot2_f32_bf16 v34, v88, v4, 0
    v_dot2_f32_bf16 v35, v92, v4, 0
    v_dot2_f32_bf16 v32, v81, v5, v32
    v_dot2_f32_bf16 v33, v85, v5, v33
    v_dot2_f32_bf16 v34, v89, v5, v34
    v_dot2_f32_bf16 v35, v93, v5, v35
    v_dot2_f32_bf16 v32, v82, v6, v32
    v_dot2_f32_bf16 v33, v86, v6, v33
    v_dot2_f32_bf16 v34, v90, v6, v34
    v_dot2_f32_bf16 v35, v94, v6, v35
    v_dot2_f32_bf16 v32, v83, v7, v32
    v_dot2_f32_bf16 v33, v87, v7, v33
    v_dot2_f32_bf16 v34, v91, v7, v34
    v_dot2_f32_bf16 v35, v95, v7, v35
    s_waitcnt vmcnt(4)
    buffer_load_dwordx4 v[68:71], v1, s[32:35], s76 offen nt
    s_addk_i32 s76, 0x1000
    v_dot2_f32_bf16 v36, v96, v4, 0
    v_dot2_f32_bf16 v37, v100, v4, 0
    v_dot2_f32_bf16 v38, v104, v4, 0
    v_dot2_f32_bf16 v39, v108, v4, 0
    v_dot2_f32_bf16 v36, v97, v5, v36
    v_dot2_f32_bf16 v37, v101, v5, v37
    v_dot2_f32_bf16 v38, v105, v5, v38
    v_dot2_f32_bf16 v39, v109, v5, v39
    v_dot2_f32_bf16 v36, v98, v6, v36
    v_dot2_f32_bf16 v37, v102, v6, v37
    v_dot2_f32_bf16 v38, v106, v6, v38
    v_dot2_f32_bf16 v39, v110, v6, v39
    v_dot2_f32_bf16 v36, v99, v7, v36
    v_dot2_f32_bf16 v37, v103, v7, v37
    v_dot2_f32_bf16 v38, v107, v7, v38
    v_dot2_f32_bf16 v39, v111, v7, v39
    s_waitcnt vmcnt(4)
    buffer_load_dwordx4 v[72:75], v1, s[32:35], s76 offen nt
    s_addk_i32 s76, 0x1000
    v_dot2_f32_bf16 v40, v112, v4, 0
    v_dot2_f32_bf16 v41, v116, v4, 0
    v_dot2_f32_bf16 v42, v120, v4, 0
    v_dot2_f32_bf16 v43, v124, v4, 0
    v_dot2_f32_bf16 v40, v113, v5, v40
    v_dot2_f32_bf16 v41, v117, v5, v41
    v_dot2_f32_bf16 v42, v121, v5, v42
    v_dot2_f32_bf16 v43, v125, v5, v43
    v_dot2_f32_bf16 v40, v114, v6, v40
    v_dot2_f32_bf16 v41, v118, v6, v41
    v_dot2_f32_bf16 v42, v122, v6, v42
    v_dot2_f32_bf16 v43, v126, v6, v43
    v_dot2_f32_bf16 v40, v115, v7, v40
    v_dot2_f32_bf16 v41, v119, v7, v41
    v_dot2_f32_bf16 v42, v123, v7, v42
    v_dot2_f32_bf16 v43, v127, v7, v43
    v_add_f32_dpp v28, v28, v28 row_mirror row_mask:0xf bank_mask:0x3
    v_add_f32_dpp v29, v29, v29 row_mirror row_mask:0xf bank_mask:0x3
    v_add_f32_dpp v30, v30, v30 row_mirror row_mask:0xf bank_mask:0x3
    v_add_f32_dpp v31, v31, v31 row_mirror row_mask:0xf bank_mask:0x3
    v_add_f32_dpp v32, v32, v32 row_mirror row_mask:0xf bank_mask:0x3
    v_add_f32_dpp v33, v33, v33 row_mirror row_mask:0xf bank_mask:0x3
    v_add_f32_dpp v34, v34, v34 row_mirror row_mask:0xf bank_mask:0x3
    v_add_f32_dpp v35, v35, v35 row_mirror row_mask:0xf bank_mask:0x3
    v_add_f32_dpp v28, v36, v36 row_mirror row_mask:0xf bank_mask:0xc
    v_add_f32_dpp v29, v37, v37 row_mirror row_mask:0xf bank_mask:0xc
    v_add_f32_dpp v30, v38, v38 row_mirror row_mask:0xf bank_mask:0xc
    v_add_f32_dpp v31, v39, v39 row_mirror row_mask:0xf bank_mask:0xc
    v_add_f32_dpp v32, v40, v40 row_mirror row_mask:0xf bank_mask:0xc
    v_add_f32_dpp v33, v41, v41 row_mirror row_mask:0xf bank_mask:0xc
    v_add_f32_dpp v34, v42, v42 row_mirror row_mask:0xf bank_mask:0xc
    v_add_f32_dpp v35, v43, v43 row_mirror row_mask:0xf bank_mask:0xc
    v_add_f32_dpp v28, v28, v28 row_half_mirror row_mask:0xf bank_mask:0x5
    v_add_f32_dpp v29, v29, v29 row_half_mirror row_mask:0xf bank_mask:0x5
    v_add_f32_dpp v30, v30, v30 row_half_mirror row_mask:0xf bank_mask:0x5
    v_add_f32_dpp v31, v31, v31 row_half_mirror row_mask:0xf bank_mask:0x5
    v_add_f32_dpp v28, v32, v32 row_half_mirror row_mask:0xf bank_mask:0xa
    v_add_f32_dpp v29, v33, v33 row_half_mirror row_mask:0xf bank_mask:0xa
    v_add_f32_dpp v30, v34, v34 row_half_mirror row_mask:0xf bank_mask:0xa
    v_add_f32_dpp v31, v35, v35 row_half_mirror row_mask:0xf bank_mask:0xa
    v_add_f32_dpp v28, v28, v28 quad_perm:[2,3,0,1] row_mask:0xf bank_mask:0xf
    v_add_f32_dpp v29, v29, v29 quad_perm:[2,3,0,1] row_mask:0xf bank_mask:0xf
    v_add_f32_dpp v30, v30, v30 quad_perm:[2,3,0,1] row_mask:0xf bank_mask:0xf
    v_add_f32_dpp v31, v31, v31 quad_perm:[2,3,0,1] row_mask:0xf bank_mask:0xf
    v_cndmask_b32 v28, v28, v30, s[86:87]
    v_cndmask_b32 v29, v29, v31, s[86:87]
    s_nop 0
    v_add_f32_dpp v28, v28, v28 quad_perm:[1,0,3,2] row_mask:0xf bank_mask:0xf
    v_add_f32_dpp v29, v29, v29 quad_perm:[1,0,3,2] row_mask:0xf bank_mask:0xf
    v_cndmask_b32 v24, v28, v29, s[88:89]
    s_waitcnt vmcnt(4)
    buffer_load_dwordx4 v[76:79], v1, s[32:35], s76 offen nt
    s_addk_i32 s76, 0x1000
    v_dot2_f32_bf16 v28, v128, v4, 0
    v_dot2_f32_bf16 v29, v132, v4, 0
    v_dot2_f32_bf16 v30, v136, v4, 0
    v_dot2_f32_bf16 v31, v140, v4, 0
    v_dot2_f32_bf16 v28, v129, v5, v28
    v_dot2_f32_bf16 v29, v133, v5, v29
    v_dot2_f32_bf16 v30, v137, v5, v30
    v_dot2_f32_bf16 v31, v141, v5, v31
    v_dot2_f32_bf16 v28, v130, v6, v28
    v_dot2_f32_bf16 v29, v134, v6, v29
    v_dot2_f32_bf16 v30, v138, v6, v30
    v_dot2_f32_bf16 v31, v142, v6, v31
    v_dot2_f32_bf16 v28, v131, v7, v28
    v_dot2_f32_bf16 v29, v135, v7, v29
    v_dot2_f32_bf16 v30, v139, v7, v30
    v_dot2_f32_bf16 v31, v143, v7, v31
    s_waitcnt vmcnt(4)
    buffer_load_dwordx4 v[80:83], v1, s[32:35], s76 offen nt
    s_addk_i32 s76, 0x1000
    v_dot2_f32_bf16 v32, v144, v4, 0
    v_dot2_f32_bf16 v33, v148, v4, 0
    v_dot2_f32_bf16 v34, v152, v4, 0
    v_dot2_f32_bf16 v35, v156, v4, 0
    v_dot2_f32_bf16 v32, v145, v5, v32
    v_dot2_f32_bf16 v33, v149, v5, v33
    v_dot2_f32_bf16 v34, v153, v5, v34
    v_dot2_f32_bf16 v35, v157, v5, v35
    v_dot2_f32_bf16 v32, v146, v6, v32
    v_dot2_f32_bf16 v33, v150, v6, v33
    v_dot2_f32_bf16 v34, v154, v6, v34
    v_dot2_f32_bf16 v35, v158, v6, v35
    v_dot2_f32_bf16 v32, v147, v7, v32
    v_dot2_f32_bf16 v33, v151, v7, v33
    v_dot2_f32_bf16 v34, v155, v7, v34
    v_dot2_f32_bf16 v35, v159, v7, v35
    s_waitcnt vmcnt(4)
    buffer_load_dwordx4 v[84:87], v1, s[32:35], s76 offen nt
    s_addk_i32 s76, 0x1000
    v_dot2_f32_bf16 v36, v160, v4, 0
    v_dot2_f32_bf16 v37, v164, v4, 0
    v_dot2_f32_bf16 v38, v168, v4, 0
    v_dot2_f32_bf16 v39, v172, v4, 0
    v_dot2_f32_bf16 v36, v161, v5, v36
    v_dot2_f32_bf16 v37, v165, v5, v37
    v_dot2_f32_bf16 v38, v169, v5, v38
    v_dot2_f32_bf16 v39, v173, v5, v39
    v_dot2_f32_bf16 v36, v162, v6, v36
    v_dot2_f32_bf16 v37, v166, v6, v37
    v_dot2_f32_bf16 v38, v170, v6, v38
    v_dot2_f32_bf16 v39, v174, v6, v39
    v_dot2_f32_bf16 v36, v163, v7, v36
    v_dot2_f32_bf16 v37, v167, v7, v37
    v_dot2_f32_bf16 v38, v171, v7, v38
    v_dot2_f32_bf16 v39, v175, v7, v39
    s_waitcnt vmcnt(4)
    buffer_load_dwordx4 v[88:91], v1, s[32:35], s76 offen nt
    s_addk_i32 s76, 0x1000
    v_dot2_f32_bf16 v40, v176, v4, 0
    v_dot2_f32_bf16 v41, v180, v4, 0
    v_dot2_f32_bf16 v42, v184, v4, 0
    v_dot2_f32_bf16 v43, v188, v4, 0
    v_dot2_f32_bf16 v40, v177, v5, v40
    v_dot2_f32_bf16 v41, v181, v5, v41
    v_dot2_f32_bf16 v42, v185, v5, v42
    v_dot2_f32_bf16 v43, v189, v5, v43
    v_dot2_f32_bf16 v40, v178, v6, v40
    v_dot2_f32_bf16 v41, v182, v6, v41
    v_dot2_f32_bf16 v42, v186, v6, v42
    v_dot2_f32_bf16 v43, v190, v6, v43
    v_dot2_f32_bf16 v40, v179, v7, v40
    v_dot2_f32_bf16 v41, v183, v7, v41
    v_dot2_f32_bf16 v42, v187, v7, v42
    v_dot2_f32_bf16 v43, v191, v7, v43
    v_add_f32_dpp v28, v28, v28 row_mirror row_mask:0xf bank_mask:0x3
    v_add_f32_dpp v29, v29, v29 row_mirror row_mask:0xf bank_mask:0x3
    v_add_f32_dpp v30, v30, v30 row_mirror row_mask:0xf bank_mask:0x3
    v_add_f32_dpp v31, v31, v31 row_mirror row_mask:0xf bank_mask:0x3
    v_add_f32_dpp v32, v32, v32 row_mirror row_mask:0xf bank_mask:0x3
    v_add_f32_dpp v33, v33, v33 row_mirror row_mask:0xf bank_mask:0x3
    v_add_f32_dpp v34, v34, v34 row_mirror row_mask:0xf bank_mask:0x3
    v_add_f32_dpp v35, v35, v35 row_mirror row_mask:0xf bank_mask:0x3
    v_add_f32_dpp v28, v36, v36 row_mirror row_mask:0xf bank_mask:0xc
    v_add_f32_dpp v29, v37, v37 row_mirror row_mask:0xf bank_mask:0xc
    v_add_f32_dpp v30, v38, v38 row_mirror row_mask:0xf bank_mask:0xc
    v_add_f32_dpp v31, v39, v39 row_mirror row_mask:0xf bank_mask:0xc
    v_add_f32_dpp v32, v40, v40 row_mirror row_mask:0xf bank_mask:0xc
    v_add_f32_dpp v33, v41, v41 row_mirror row_mask:0xf bank_mask:0xc
    v_add_f32_dpp v34, v42, v42 row_mirror row_mask:0xf bank_mask:0xc
    v_add_f32_dpp v35, v43, v43 row_mirror row_mask:0xf bank_mask:0xc
    v_add_f32_dpp v28, v28, v28 row_half_mirror row_mask:0xf bank_mask:0x5
    v_add_f32_dpp v29, v29, v29 row_half_mirror row_mask:0xf bank_mask:0x5
    v_add_f32_dpp v30, v30, v30 row_half_mirror row_mask:0xf bank_mask:0x5
    v_add_f32_dpp v31, v31, v31 row_half_mirror row_mask:0xf bank_mask:0x5
    v_add_f32_dpp v28, v32, v32 row_half_mirror row_mask:0xf bank_mask:0xa
    v_add_f32_dpp v29, v33, v33 row_half_mirror row_mask:0xf bank_mask:0xa
    v_add_f32_dpp v30, v34, v34 row_half_mirror row_mask:0xf bank_mask:0xa
    v_add_f32_dpp v31, v35, v35 row_half_mirror row_mask:0xf bank_mask:0xa
    v_add_f32_dpp v28, v28, v28 quad_perm:[2,3,0,1] row_mask:0xf bank_mask:0xf
    v_add_f32_dpp v29, v29, v29 quad_perm:[2,3,0,1] row_mask:0xf bank_mask:0xf
    v_add_f32_dpp v30, v30, v30 quad_perm:[2,3,0,1] row_mask:0xf bank_mask:0xf
    v_add_f32_dpp v31, v31, v31 quad_perm:[2,3,0,1] row_mask:0xf bank_mask:0xf
    v_cndmask_b32 v28, v28, v30, s[86:87]
    v_cndmask_b32 v29, v29, v31, s[86:87]
    s_nop 0
    v_add_f32_dpp v28, v28, v28 quad_perm:[1,0,3,2] row_mask:0xf bank_mask:0xf
    v_add_f32_dpp v29, v29, v29 quad_perm:[1,0,3,2] row_mask:0xf bank_mask:0xf
    v_cndmask_b32 v25, v28, v29, s[88:89]
    s_waitcnt vmcnt(4)
    buffer_load_dwordx4 v[92:95], v1, s[32:35], s76 offen nt
    s_addk_i32 s76, 0x1000
    v_dot2_f32_bf16 v28, v192, v4, 0
    v_dot2_f32_bf16 v29, v196, v4, 0
    v_dot2_f32_bf16 v30, v200, v4, 0
    v_dot2_f32_bf16 v31, v204, v4, 0
    v_dot2_f32_bf16 v28, v193, v5, v28
    v_dot2_f32_bf16 v29, v197, v5, v29
    v_dot2_f32_bf16 v30, v201, v5, v30
    v_dot2_f32_bf16 v31, v205, v5, v31
    v_dot2_f32_bf16 v28, v194, v6, v28
    v_dot2_f32_bf16 v29, v198, v6, v29
    v_dot2_f32_bf16 v30, v202, v6, v30
    v_dot2_f32_bf16 v31, v206, v6, v31
    v_dot2_f32_bf16 v28, v195, v7, v28
    v_dot2_f32_bf16 v29, v199, v7, v29
    v_dot2_f32_bf16 v30, v203, v7, v30
    v_dot2_f32_bf16 v31, v207, v7, v31
    s_waitcnt vmcnt(4)
    buffer_load_dwordx4 v[96:99], v1, s[32:35], s76 offen nt
    s_addk_i32 s76, 0x1000
    v_dot2_f32_bf16 v32, v208, v4, 0
    v_dot2_f32_bf16 v33, v212, v4, 0
    v_dot2_f32_bf16 v34, v216, v4, 0
    v_dot2_f32_bf16 v35, v220, v4, 0
    v_dot2_f32_bf16 v32, v209, v5, v32
    v_dot2_f32_bf16 v33, v213, v5, v33
    v_dot2_f32_bf16 v34, v217, v5, v34
    v_dot2_f32_bf16 v35, v221, v5, v35
    v_dot2_f32_bf16 v32, v210, v6, v32
    v_dot2_f32_bf16 v33, v214, v6, v33
    v_dot2_f32_bf16 v34, v218, v6, v34
    v_dot2_f32_bf16 v35, v222, v6, v35
    v_dot2_f32_bf16 v32, v211, v7, v32
    v_dot2_f32_bf16 v33, v215, v7, v33
    v_dot2_f32_bf16 v34, v219, v7, v34
    v_dot2_f32_bf16 v35, v223, v7, v35
    s_waitcnt vmcnt(4)
    buffer_load_dwordx4 v[100:103], v1, s[32:35], s76 offen nt
    s_addk_i32 s76, 0x1000
    v_dot2_f32_bf16 v36, v224, v4, 0
    v_dot2_f32_bf16 v37, v228, v4, 0
    v_dot2_f32_bf16 v38, v232, v4, 0
    v_dot2_f32_bf16 v39, v236, v4, 0
    v_dot2_f32_bf16 v36, v225, v5, v36
    v_dot2_f32_bf16 v37, v229, v5, v37
    v_dot2_f32_bf16 v38, v233, v5, v38
    v_dot2_f32_bf16 v39, v237, v5, v39
    v_dot2_f32_bf16 v36, v226, v6, v36
    v_dot2_f32_bf16 v37, v230, v6, v37
    v_dot2_f32_bf16 v38, v234, v6, v38
    v_dot2_f32_bf16 v39, v238, v6, v39
    v_dot2_f32_bf16 v36, v227, v7, v36
    v_dot2_f32_bf16 v37, v231, v7, v37
    v_dot2_f32_bf16 v38, v235, v7, v38
    v_dot2_f32_bf16 v39, v239, v7, v39
    s_waitcnt vmcnt(4)
    buffer_load_dwordx4 v[104:107], v1, s[32:35], s76 offen nt
    s_addk_i32 s76, 0x1000
    v_dot2_f32_bf16 v40, v240, v4, 0
    v_dot2_f32_bf16 v41, v244, v4, 0
    v_dot2_f32_bf16 v42, v248, v4, 0
    v_dot2_f32_bf16 v43, v252, v4, 0
    v_dot2_f32_bf16 v40, v241, v5, v40
    v_dot2_f32_bf16 v41, v245, v5, v41
    v_dot2_f32_bf16 v42, v249, v5, v42
    v_dot2_f32_bf16 v43, v253, v5, v43
    v_dot2_f32_bf16 v40, v242, v6, v40
    v_dot2_f32_bf16 v41, v246, v6, v41
    v_dot2_f32_bf16 v42, v250, v6, v42
    v_dot2_f32_bf16 v43, v254, v6, v43
    v_dot2_f32_bf16 v40, v243, v7, v40
    v_dot2_f32_bf16 v41, v247, v7, v41
    v_dot2_f32_bf16 v42, v251, v7, v42
    v_dot2_f32_bf16 v43, v255, v7, v43
    v_add_f32_dpp v28, v28, v28 row_mirror row_mask:0xf bank_mask:0x3
    v_add_f32_dpp v29, v29, v29 row_mirror row_mask:0xf bank_mask:0x3
    v_add_f32_dpp v30, v30, v30 row_mirror row_mask:0xf bank_mask:0x3
    v_add_f32_dpp v31, v31, v31 row_mirror row_mask:0xf bank_mask:0x3
    v_add_f32_dpp v32, v32, v32 row_mirror row_mask:0xf bank_mask:0x3
    v_add_f32_dpp v33, v33, v33 row_mirror row_mask:0xf bank_mask:0x3
    v_add_f32_dpp v34, v34, v34 row_mirror row_mask:0xf bank_mask:0x3
    v_add_f32_dpp v35, v35, v35 row_mirror row_mask:0xf bank_mask:0x3
    v_add_f32_dpp v28, v36, v36 row_mirror row_mask:0xf bank_mask:0xc
    v_add_f32_dpp v29, v37, v37 row_mirror row_mask:0xf bank_mask:0xc
    v_add_f32_dpp v30, v38, v38 row_mirror row_mask:0xf bank_mask:0xc
    v_add_f32_dpp v31, v39, v39 row_mirror row_mask:0xf bank_mask:0xc
    v_add_f32_dpp v32, v40, v40 row_mirror row_mask:0xf bank_mask:0xc
    v_add_f32_dpp v33, v41, v41 row_mirror row_mask:0xf bank_mask:0xc
    v_add_f32_dpp v34, v42, v42 row_mirror row_mask:0xf bank_mask:0xc
    v_add_f32_dpp v35, v43, v43 row_mirror row_mask:0xf bank_mask:0xc
    v_add_f32_dpp v28, v28, v28 row_half_mirror row_mask:0xf bank_mask:0x5
    v_add_f32_dpp v29, v29, v29 row_half_mirror row_mask:0xf bank_mask:0x5
    v_add_f32_dpp v30, v30, v30 row_half_mirror row_mask:0xf bank_mask:0x5
    v_add_f32_dpp v31, v31, v31 row_half_mirror row_mask:0xf bank_mask:0x5
    v_add_f32_dpp v28, v32, v32 row_half_mirror row_mask:0xf bank_mask:0xa
    v_add_f32_dpp v29, v33, v33 row_half_mirror row_mask:0xf bank_mask:0xa
    v_add_f32_dpp v30, v34, v34 row_half_mirror row_mask:0xf bank_mask:0xa
    v_add_f32_dpp v31, v35, v35 row_half_mirror row_mask:0xf bank_mask:0xa
    v_add_f32_dpp v28, v28, v28 quad_perm:[2,3,0,1] row_mask:0xf bank_mask:0xf
    v_add_f32_dpp v29, v29, v29 quad_perm:[2,3,0,1] row_mask:0xf bank_mask:0xf
    v_add_f32_dpp v30, v30, v30 quad_perm:[2,3,0,1] row_mask:0xf bank_mask:0xf
    v_add_f32_dpp v31, v31, v31 quad_perm:[2,3,0,1] row_mask:0xf bank_mask:0xf
    v_cndmask_b32 v28, v28, v30, s[86:87]
    v_cndmask_b32 v29, v29, v31, s[86:87]
    s_nop 0
    v_add_f32_dpp v28, v28, v28 quad_perm:[1,0,3,2] row_mask:0xf bank_mask:0xf
    v_add_f32_dpp v29, v29, v29 quad_perm:[1,0,3,2] row_mask:0xf bank_mask:0xf
    v_cndmask_b32 v26, v28, v29, s[88:89]
    s_waitcnt vmcnt(4)
    buffer_load_dwordx4 v[108:111], v1, s[32:35], s76 offen nt
    s_addk_i32 s76, 0x1000
    v_dot2_f32_bf16 v28, v64, v4, 0
    v_dot2_f32_bf16 v29, v68, v4, 0
    v_dot2_f32_bf16 v30, v72, v4, 0
    v_dot2_f32_bf16 v31, v76, v4, 0
    v_dot2_f32_bf16 v28, v65, v5, v28
    v_dot2_f32_bf16 v29, v69, v5, v29
    v_dot2_f32_bf16 v30, v73, v5, v30
    v_dot2_f32_bf16 v31, v77, v5, v31
    v_dot2_f32_bf16 v28, v66, v6, v28
    v_dot2_f32_bf16 v29, v70, v6, v29
    v_dot2_f32_bf16 v30, v74, v6, v30
    v_dot2_f32_bf16 v31, v78, v6, v31
    v_dot2_f32_bf16 v28, v67, v7, v28
    v_dot2_f32_bf16 v29, v71, v7, v29
    v_dot2_f32_bf16 v30, v75, v7, v30
    v_dot2_f32_bf16 v31, v79, v7, v31
    s_waitcnt vmcnt(4)
    buffer_load_dwordx4 v[112:115], v1, s[32:35], s76 offen nt
    s_addk_i32 s76, 0x1000
    v_dot2_f32_bf16 v32, v80, v4, 0
    v_dot2_f32_bf16 v33, v84, v4, 0
    v_dot2_f32_bf16 v34, v88, v4, 0
    v_dot2_f32_bf16 v35, v92, v4, 0
    v_dot2_f32_bf16 v32, v81, v5, v32
    v_dot2_f32_bf16 v33, v85, v5, v33
    v_dot2_f32_bf16 v34, v89, v5, v34
    v_dot2_f32_bf16 v35, v93, v5, v35
    v_dot2_f32_bf16 v32, v82, v6, v32
    v_dot2_f32_bf16 v33, v86, v6, v33
    v_dot2_f32_bf16 v34, v90, v6, v34
    v_dot2_f32_bf16 v35, v94, v6, v35
    v_dot2_f32_bf16 v32, v83, v7, v32
    v_dot2_f32_bf16 v33, v87, v7, v33
    v_dot2_f32_bf16 v34, v91, v7, v34
    v_dot2_f32_bf16 v35, v95, v7, v35
    s_waitcnt vmcnt(4)
    buffer_load_dwordx4 v[116:119], v1, s[32:35], s76 offen nt
    s_addk_i32 s76, 0x1000
    s_waitcnt vmcnt(4)
    buffer_load_dwordx4 v[120:123], v1, s[32:35], s76 offen nt
    s_addk_i32 s76, 0x1000
    s_waitcnt vmcnt(4)
    buffer_load_dwordx4 v[124:127], v1, s[32:35], s76 offen nt
    s_addk_i32 s76, 0x1000
    s_waitcnt vmcnt(4)
    s_mov_b32 s76, 0
    buffer_load_dwordx4 v[128:131], v1, s[36:39], s76 offen nt
    s_addk_i32 s76, 0x1000
    v_dot2_f32_bf16 v36, v96, v4, 0
    v_dot2_f32_bf16 v37, v100, v4, 0
    v_dot2_f32_bf16 v38, v104, v4, 0
    v_dot2_f32_bf16 v39, v108, v4, 0
    v_dot2_f32_bf16 v36, v97, v5, v36
    v_dot2_f32_bf16 v37, v101, v5, v37
    v_dot2_f32_bf16 v38, v105, v5, v38
    v_dot2_f32_bf16 v39, v109, v5, v39
    v_dot2_f32_bf16 v36, v98, v6, v36
    v_dot2_f32_bf16 v37, v102, v6, v37
    v_dot2_f32_bf16 v38, v106, v6, v38
    v_dot2_f32_bf16 v39, v110, v6, v39
    v_dot2_f32_bf16 v36, v99, v7, v36
    v_dot2_f32_bf16 v37, v103, v7, v37
    v_dot2_f32_bf16 v38, v107, v7, v38
    v_dot2_f32_bf16 v39, v111, v7, v39
    s_waitcnt vmcnt(4)
    buffer_load_dwordx4 v[132:135], v1, s[36:39], s76 offen nt
    s_addk_i32 s76, 0x1000
    s_waitcnt vmcnt(4)
    buffer_load_dwordx4 v[136:139], v1, s[36:39], s76 offen nt
    s_addk_i32 s76, 0x1000
    s_waitcnt vmcnt(4)
    buffer_load_dwordx4 v[140:143], v1, s[36:39], s76 offen nt
    s_addk_i32 s76, 0x1000
    s_waitcnt vmcnt(4)
    buffer_load_dwordx4 v[144:147], v1, s[36:39], s76 offen nt
    s_addk_i32 s76, 0x1000
    v_dot2_f32_bf16 v40, v112, v4, 0
    v_dot2_f32_bf16 v41, v116, v4, 0
    v_dot2_f32_bf16 v42, v120, v4, 0
    v_dot2_f32_bf16 v43, v124, v4, 0
    v_dot2_f32_bf16 v40, v113, v5, v40
    v_dot2_f32_bf16 v41, v117, v5, v41
    v_dot2_f32_bf16 v42, v121, v5, v42
    v_dot2_f32_bf16 v43, v125, v5, v43
    v_dot2_f32_bf16 v40, v114, v6, v40
    v_dot2_f32_bf16 v41, v118, v6, v41
    v_dot2_f32_bf16 v42, v122, v6, v42
    v_dot2_f32_bf16 v43, v126, v6, v43
    v_dot2_f32_bf16 v40, v115, v7, v40
    v_dot2_f32_bf16 v41, v119, v7, v41
    v_dot2_f32_bf16 v42, v123, v7, v42
    v_dot2_f32_bf16 v43, v127, v7, v43
    v_add_f32_dpp v28, v28, v28 row_mirror row_mask:0xf bank_mask:0x3
    v_add_f32_dpp v29, v29, v29 row_mirror row_mask:0xf bank_mask:0x3
    v_add_f32_dpp v30, v30, v30 row_mirror row_mask:0xf bank_mask:0x3
    v_add_f32_dpp v31, v31, v31 row_mirror row_mask:0xf bank_mask:0x3
    v_add_f32_dpp v32, v32, v32 row_mirror row_mask:0xf bank_mask:0x3
    v_add_f32_dpp v33, v33, v33 row_mirror row_mask:0xf bank_mask:0x3
    v_add_f32_dpp v34, v34, v34 row_mirror row_mask:0xf bank_mask:0x3
    v_add_f32_dpp v35, v35, v35 row_mirror row_mask:0xf bank_mask:0x3
    v_add_f32_dpp v28, v36, v36 row_mirror row_mask:0xf bank_mask:0xc
    v_add_f32_dpp v29, v37, v37 row_mirror row_mask:0xf bank_mask:0xc
    v_add_f32_dpp v30, v38, v38 row_mirror row_mask:0xf bank_mask:0xc
    v_add_f32_dpp v31, v39, v39 row_mirror row_mask:0xf bank_mask:0xc
    v_add_f32_dpp v32, v40, v40 row_mirror row_mask:0xf bank_mask:0xc
    v_add_f32_dpp v33, v41, v41 row_mirror row_mask:0xf bank_mask:0xc
    v_add_f32_dpp v34, v42, v42 row_mirror row_mask:0xf bank_mask:0xc
    v_add_f32_dpp v35, v43, v43 row_mirror row_mask:0xf bank_mask:0xc
    v_add_f32_dpp v28, v28, v28 row_half_mirror row_mask:0xf bank_mask:0x5
    v_add_f32_dpp v29, v29, v29 row_half_mirror row_mask:0xf bank_mask:0x5
    v_add_f32_dpp v30, v30, v30 row_half_mirror row_mask:0xf bank_mask:0x5
    v_add_f32_dpp v31, v31, v31 row_half_mirror row_mask:0xf bank_mask:0x5
    v_add_f32_dpp v28, v32, v32 row_half_mirror row_mask:0xf bank_mask:0xa
    v_add_f32_dpp v29, v33, v33 row_half_mirror row_mask:0xf bank_mask:0xa
    v_add_f32_dpp v30, v34, v34 row_half_mirror row_mask:0xf bank_mask:0xa
    v_add_f32_dpp v31, v35, v35 row_half_mirror row_mask:0xf bank_mask:0xa
    v_add_f32_dpp v28, v28, v28 quad_perm:[2,3,0,1] row_mask:0xf bank_mask:0xf
    v_add_f32_dpp v29, v29, v29 quad_perm:[2,3,0,1] row_mask:0xf bank_mask:0xf
    v_add_f32_dpp v30, v30, v30 quad_perm:[2,3,0,1] row_mask:0xf bank_mask:0xf
    v_add_f32_dpp v31, v31, v31 quad_perm:[2,3,0,1] row_mask:0xf bank_mask:0xf
    v_cndmask_b32 v28, v28, v30, s[86:87]
    v_cndmask_b32 v29, v29, v31, s[86:87]
    s_nop 0
    v_add_f32_dpp v28, v28, v28 quad_perm:[1,0,3,2] row_mask:0xf bank_mask:0xf
    v_add_f32_dpp v29, v29, v29 quad_perm:[1,0,3,2] row_mask:0xf bank_mask:0xf
    v_cndmask_b32 v27, v28, v29, s[88:89]
    v_cvt_pk_bf16_f32 v44, v24, v25
    v_cvt_pk_bf16_f32 v45, v26, v27
    v_lshlrev_b32 v24, 16, v44
    v_and_b32 v25, 0xffff0000, v44
    v_lshlrev_b32 v26, 16, v45
    v_and_b32 v27, 0xffff0000, v45
    v_mul_f32 v24, 0x3db504f3, v24
    v_mul_f32 v25, 0x3db504f3, v25
    v_mul_f32 v26, 0x3db504f3, v26
    v_mul_f32 v27, 0x3db504f3, v27
    v_cvt_pk_bf16_f32 v44, v24, v25
    v_cvt_pk_bf16_f32 v45, v26, v27
    v_lshlrev_b32 v24, 16, v44
    v_and_b32 v25, 0xffff0000, v44
    v_lshlrev_b32 v26, 16, v45
    v_and_b32 v27, 0xffff0000, v45
    v_max3_f32 v44, v24, v25, v26
    v_max_f32 v44, v44, v27
    s_nop 1
    v_max_f32_dpp v44, v44, v44 row_mirror row_mask:0xf bank_mask:0xf
    s_nop 1
    v_max_f32_dpp v44, v44, v44 row_half_mirror row_mask:0xf bank_mask:0xf
    s_nop 1
    v_max_f32_dpp v44, v44, v44 quad_perm:[2,3,0,1] row_mask:0xf bank_mask:0xf
    s_nop 1
    v_max_f32_dpp v44, v44, v44 quad_perm:[1,0,3,2] row_mask:0xf bank_mask:0xf
    s_nop 1
    v_max_f32_dpp v44, v44, v44 row_bcast:15 row_mask:0xa bank_mask:0xf
    s_nop 1
    v_max_f32_dpp v44, v44, v44 row_bcast:31 row_mask:0xc bank_mask:0xf
    s_nop 0
    v_readlane_b32 s78, v44, 63
    s_nop 1
    v_subrev_f32 v24, s78, v24
    v_subrev_f32 v25, s78, v25
    v_subrev_f32 v26, s78, v26
    v_subrev_f32 v27, s78, v27
    v_mul_f32 v24, 0x3fb8aa3b, v24
    v_mul_f32 v25, 0x3fb8aa3b, v25
    v_mul_f32 v26, 0x3fb8aa3b, v26
    v_mul_f32 v27, 0x3fb8aa3b, v27
    v_exp_f32 v24, v24
    v_exp_f32 v25, v25
    v_exp_f32 v26, v26
    v_exp_f32 v27, v27
    v_add_f32 v44, v24, v25
    v_add_f32 v45, v26, v27
    v_add_f32 v44, v44, v45
    v_cvt_pk_bf16_f32 v24, v24, v24
    v_cvt_pk_bf16_f32 v25, v25, v25
    v_cvt_pk_bf16_f32 v26, v26, v26
    v_cvt_pk_bf16_f32 v27, v27, v27
    v_and_b32_dpp v12, v24, v8 row_newbcast:0 row_mask:0xf bank_mask:0xf
    v_and_b32_dpp v13, v24, v9 row_newbcast:0 row_mask:0xf bank_mask:0xf
    v_and_b32_dpp v14, v24, v10 row_newbcast:0 row_mask:0xf bank_mask:0xf
    v_and_b32_dpp v15, v24, v11 row_newbcast:0 row_mask:0xf bank_mask:0xf
    v_add_f32_dpp v44, v44, v44 row_mirror row_mask:0xf bank_mask:0xf
    s_nop 1
    v_add_f32_dpp v44, v44, v44 row_half_mirror row_mask:0xf bank_mask:0xf
    s_nop 1
    v_add_f32_dpp v44, v44, v44 quad_perm:[2,3,0,1] row_mask:0xf bank_mask:0xf
    s_nop 1
    v_add_f32_dpp v44, v44, v44 quad_perm:[1,0,3,2] row_mask:0xf bank_mask:0xf
    s_nop 1
    v_add_f32_dpp v44, v44, v44 row_bcast:15 row_mask:0xa bank_mask:0xf
    s_nop 1
    v_add_f32_dpp v44, v44, v44 row_bcast:31 row_mask:0xc bank_mask:0xf
    s_nop 0
    v_readlane_b32 s79, v44, 63
    v_mov_b32 v44, s78
    s_nop 0
    v_mov_b32 v45, s79
    v_mov_b32 v46, 1
    v_mov_b32 v47, 0
    s_lshl_b32 s75, s3, 4
    v_mov_b32 v48, s75
    ds_write_b128 v48, v[44:47] offset:5120
    v_and_b32_dpp v16, v24, v8 row_newbcast:1 row_mask:0xf bank_mask:0xf
    v_and_b32_dpp v17, v24, v9 row_newbcast:1 row_mask:0xf bank_mask:0xf
    v_and_b32_dpp v18, v24, v10 row_newbcast:1 row_mask:0xf bank_mask:0xf
    v_and_b32_dpp v19, v24, v11 row_newbcast:1 row_mask:0xf bank_mask:0xf
    s_waitcnt vmcnt(4)
    buffer_load_dwordx4 v[148:151], v1, s[36:39], s76 offen nt
    s_addk_i32 s76, 0x1000
    v_mfma_f32_16x16x32_bf16 v[20:23], v[12:15], v[128:131], 0
    v_and_b32_dpp v12, v24, v8 row_newbcast:2 row_mask:0xf bank_mask:0xf
    v_and_b32_dpp v13, v24, v9 row_newbcast:2 row_mask:0xf bank_mask:0xf
    v_and_b32_dpp v14, v24, v10 row_newbcast:2 row_mask:0xf bank_mask:0xf
    v_and_b32_dpp v15, v24, v11 row_newbcast:2 row_mask:0xf bank_mask:0xf
    s_waitcnt vmcnt(4)
    buffer_load_dwordx4 v[152:155], v1, s[36:39], s76 offen nt
    s_addk_i32 s76, 0x1000
    v_mfma_f32_16x16x32_bf16 v[20:23], v[16:19], v[132:135], v[20:23]
    v_and_b32_dpp v16, v24, v8 row_newbcast:3 row_mask:0xf bank_mask:0xf
    v_and_b32_dpp v17, v24, v9 row_newbcast:3 row_mask:0xf bank_mask:0xf
    v_and_b32_dpp v18, v24, v10 row_newbcast:3 row_mask:0xf bank_mask:0xf
    v_and_b32_dpp v19, v24, v11 row_newbcast:3 row_mask:0xf bank_mask:0xf
    s_waitcnt vmcnt(4)
    buffer_load_dwordx4 v[156:159], v1, s[36:39], s76 offen nt
    s_addk_i32 s76, 0x1000
    v_mfma_f32_16x16x32_bf16 v[20:23], v[12:15], v[136:139], v[20:23]
    v_and_b32_dpp v12, v24, v8 row_newbcast:4 row_mask:0xf bank_mask:0xf
    v_and_b32_dpp v13, v24, v9 row_newbcast:4 row_mask:0xf bank_mask:0xf
    v_and_b32_dpp v14, v24, v10 row_newbcast:4 row_mask:0xf bank_mask:0xf
    v_and_b32_dpp v15, v24, v11 row_newbcast:4 row_mask:0xf bank_mask:0xf
    s_waitcnt vmcnt(4)
    buffer_load_dwordx4 v[160:163], v1, s[36:39], s76 offen nt
    s_addk_i32 s76, 0x1000
    v_mfma_f32_16x16x32_bf16 v[20:23], v[16:19], v[140:143], v[20:23]
    v_and_b32_dpp v16, v24, v8 row_newbcast:5 row_mask:0xf bank_mask:0xf
    v_and_b32_dpp v17, v24, v9 row_newbcast:5 row_mask:0xf bank_mask:0xf
    v_and_b32_dpp v18, v24, v10 row_newbcast:5 row_mask:0xf bank_mask:0xf
    v_and_b32_dpp v19, v24, v11 row_newbcast:5 row_mask:0xf bank_mask:0xf
    s_waitcnt vmcnt(4)
    buffer_load_dwordx4 v[164:167], v1, s[36:39], s76 offen nt
    s_addk_i32 s76, 0x1000
    v_mfma_f32_16x16x32_bf16 v[20:23], v[12:15], v[144:147], v[20:23]
    v_and_b32_dpp v12, v24, v8 row_newbcast:6 row_mask:0xf bank_mask:0xf
    v_and_b32_dpp v13, v24, v9 row_newbcast:6 row_mask:0xf bank_mask:0xf
    v_and_b32_dpp v14, v24, v10 row_newbcast:6 row_mask:0xf bank_mask:0xf
    v_and_b32_dpp v15, v24, v11 row_newbcast:6 row_mask:0xf bank_mask:0xf
    s_waitcnt vmcnt(4)
    buffer_load_dwordx4 v[168:171], v1, s[36:39], s76 offen nt
    s_addk_i32 s76, 0x1000
    v_mfma_f32_16x16x32_bf16 v[20:23], v[16:19], v[148:151], v[20:23]
    v_and_b32_dpp v16, v24, v8 row_newbcast:7 row_mask:0xf bank_mask:0xf
    v_and_b32_dpp v17, v24, v9 row_newbcast:7 row_mask:0xf bank_mask:0xf
    v_and_b32_dpp v18, v24, v10 row_newbcast:7 row_mask:0xf bank_mask:0xf
    v_and_b32_dpp v19, v24, v11 row_newbcast:7 row_mask:0xf bank_mask:0xf
    s_waitcnt vmcnt(4)
    buffer_load_dwordx4 v[172:175], v1, s[36:39], s76 offen nt
    s_addk_i32 s76, 0x1000
    v_mfma_f32_16x16x32_bf16 v[20:23], v[12:15], v[152:155], v[20:23]
    v_and_b32_dpp v12, v24, v8 row_newbcast:8 row_mask:0xf bank_mask:0xf
    v_and_b32_dpp v13, v24, v9 row_newbcast:8 row_mask:0xf bank_mask:0xf
    v_and_b32_dpp v14, v24, v10 row_newbcast:8 row_mask:0xf bank_mask:0xf
    v_and_b32_dpp v15, v24, v11 row_newbcast:8 row_mask:0xf bank_mask:0xf
    s_waitcnt vmcnt(4)
    buffer_load_dwordx4 v[176:179], v1, s[36:39], s76 offen nt
    s_addk_i32 s76, 0x1000
    v_mfma_f32_16x16x32_bf16 v[20:23], v[16:19], v[156:159], v[20:23]
    v_and_b32_dpp v16, v24, v8 row_newbcast:9 row_mask:0xf bank_mask:0xf
    v_and_b32_dpp v17, v24, v9 row_newbcast:9 row_mask:0xf bank_mask:0xf
    v_and_b32_dpp v18, v24, v10 row_newbcast:9 row_mask:0xf bank_mask:0xf
    v_and_b32_dpp v19, v24, v11 row_newbcast:9 row_mask:0xf bank_mask:0xf
    s_waitcnt vmcnt(4)
    buffer_load_dwordx4 v[180:183], v1, s[36:39], s76 offen nt
    s_addk_i32 s76, 0x1000
    v_mfma_f32_16x16x32_bf16 v[20:23], v[12:15], v[160:163], v[20:23]
    v_and_b32_dpp v12, v24, v8 row_newbcast:10 row_mask:0xf bank_mask:0xf
    v_and_b32_dpp v13, v24, v9 row_newbcast:10 row_mask:0xf bank_mask:0xf
    v_and_b32_dpp v14, v24, v10 row_newbcast:10 row_mask:0xf bank_mask:0xf
    v_and_b32_dpp v15, v24, v11 row_newbcast:10 row_mask:0xf bank_mask:0xf
    s_waitcnt vmcnt(4)
    buffer_load_dwordx4 v[184:187], v1, s[36:39], s76 offen nt
    s_addk_i32 s76, 0x1000
    v_mfma_f32_16x16x32_bf16 v[20:23], v[16:19], v[164:167], v[20:23]
    v_and_b32_dpp v16, v24, v8 row_newbcast:11 row_mask:0xf bank_mask:0xf
    v_and_b32_dpp v17, v24, v9 row_newbcast:11 row_mask:0xf bank_mask:0xf
    v_and_b32_dpp v18, v24, v10 row_newbcast:11 row_mask:0xf bank_mask:0xf
    v_and_b32_dpp v19, v24, v11 row_newbcast:11 row_mask:0xf bank_mask:0xf
    s_waitcnt vmcnt(4)
    buffer_load_dwordx4 v[188:191], v1, s[36:39], s76 offen nt
    s_addk_i32 s76, 0x1000
    v_mfma_f32_16x16x32_bf16 v[20:23], v[12:15], v[168:171], v[20:23]
    v_and_b32_dpp v12, v24, v8 row_newbcast:12 row_mask:0xf bank_mask:0xf
    v_and_b32_dpp v13, v24, v9 row_newbcast:12 row_mask:0xf bank_mask:0xf
    v_and_b32_dpp v14, v24, v10 row_newbcast:12 row_mask:0xf bank_mask:0xf
    v_and_b32_dpp v15, v24, v11 row_newbcast:12 row_mask:0xf bank_mask:0xf
    s_waitcnt vmcnt(4)
    buffer_load_dwordx4 v[192:195], v1, s[36:39], s76 offen nt
    s_addk_i32 s76, 0x1000
    v_mfma_f32_16x16x32_bf16 v[20:23], v[16:19], v[172:175], v[20:23]
    v_and_b32_dpp v16, v24, v8 row_newbcast:13 row_mask:0xf bank_mask:0xf
    v_and_b32_dpp v17, v24, v9 row_newbcast:13 row_mask:0xf bank_mask:0xf
    v_and_b32_dpp v18, v24, v10 row_newbcast:13 row_mask:0xf bank_mask:0xf
    v_and_b32_dpp v19, v24, v11 row_newbcast:13 row_mask:0xf bank_mask:0xf
    s_waitcnt vmcnt(4)
    buffer_load_dwordx4 v[196:199], v1, s[36:39], s76 offen nt
    s_addk_i32 s76, 0x1000
    v_mfma_f32_16x16x32_bf16 v[20:23], v[12:15], v[176:179], v[20:23]
    v_and_b32_dpp v12, v24, v8 row_newbcast:14 row_mask:0xf bank_mask:0xf
    v_and_b32_dpp v13, v24, v9 row_newbcast:14 row_mask:0xf bank_mask:0xf
    v_and_b32_dpp v14, v24, v10 row_newbcast:14 row_mask:0xf bank_mask:0xf
    v_and_b32_dpp v15, v24, v11 row_newbcast:14 row_mask:0xf bank_mask:0xf
    s_waitcnt vmcnt(4)
    buffer_load_dwordx4 v[200:203], v1, s[36:39], s76 offen nt
    s_addk_i32 s76, 0x1000
    v_mfma_f32_16x16x32_bf16 v[20:23], v[16:19], v[180:183], v[20:23]
    v_and_b32_dpp v16, v24, v8 row_newbcast:15 row_mask:0xf bank_mask:0xf
    v_and_b32_dpp v17, v24, v9 row_newbcast:15 row_mask:0xf bank_mask:0xf
    v_and_b32_dpp v18, v24, v10 row_newbcast:15 row_mask:0xf bank_mask:0xf
    v_and_b32_dpp v19, v24, v11 row_newbcast:15 row_mask:0xf bank_mask:0xf
    s_waitcnt vmcnt(4)
    buffer_load_dwordx4 v[204:207], v1, s[36:39], s76 offen nt
    s_addk_i32 s76, 0x1000
    v_mfma_f32_16x16x32_bf16 v[20:23], v[12:15], v[184:187], v[20:23]
    v_and_b32_dpp v12, v25, v8 row_newbcast:0 row_mask:0xf bank_mask:0xf
    v_and_b32_dpp v13, v25, v9 row_newbcast:0 row_mask:0xf bank_mask:0xf
    v_and_b32_dpp v14, v25, v10 row_newbcast:0 row_mask:0xf bank_mask:0xf
    v_and_b32_dpp v15, v25, v11 row_newbcast:0 row_mask:0xf bank_mask:0xf
    s_waitcnt vmcnt(4)
    buffer_load_dwordx4 v[208:211], v1, s[36:39], s76 offen nt
    s_addk_i32 s76, 0x1000
    v_mfma_f32_16x16x32_bf16 v[20:23], v[16:19], v[188:191], v[20:23]
    v_and_b32_dpp v16, v25, v8 row_newbcast:1 row_mask:0xf bank_mask:0xf
    v_and_b32_dpp v17, v25, v9 row_newbcast:1 row_mask:0xf bank_mask:0xf
    v_and_b32_dpp v18, v25, v10 row_newbcast:1 row_mask:0xf bank_mask:0xf
    v_and_b32_dpp v19, v25, v11 row_newbcast:1 row_mask:0xf bank_mask:0xf
    s_waitcnt vmcnt(4)
    buffer_load_dwordx4 v[212:215], v1, s[36:39], s76 offen nt
    s_addk_i32 s76, 0x1000
    v_mfma_f32_16x16x32_bf16 v[20:23], v[12:15], v[192:195], v[20:23]
    v_and_b32_dpp v12, v25, v8 row_newbcast:2 row_mask:0xf bank_mask:0xf
    v_and_b32_dpp v13, v25, v9 row_newbcast:2 row_mask:0xf bank_mask:0xf
    v_and_b32_dpp v14, v25, v10 row_newbcast:2 row_mask:0xf bank_mask:0xf
    v_and_b32_dpp v15, v25, v11 row_newbcast:2 row_mask:0xf bank_mask:0xf
    s_waitcnt vmcnt(4)
    buffer_load_dwordx4 v[216:219], v1, s[36:39], s76 offen nt
    s_addk_i32 s76, 0x1000
    v_mfma_f32_16x16x32_bf16 v[20:23], v[16:19], v[196:199], v[20:23]
    v_and_b32_dpp v16, v25, v8 row_newbcast:3 row_mask:0xf bank_mask:0xf
    v_and_b32_dpp v17, v25, v9 row_newbcast:3 row_mask:0xf bank_mask:0xf
    v_and_b32_dpp v18, v25, v10 row_newbcast:3 row_mask:0xf bank_mask:0xf
    v_and_b32_dpp v19, v25, v11 row_newbcast:3 row_mask:0xf bank_mask:0xf
    s_waitcnt vmcnt(4)
    buffer_load_dwordx4 v[220:223], v1, s[36:39], s76 offen nt
    s_addk_i32 s76, 0x1000
    v_mfma_f32_16x16x32_bf16 v[20:23], v[12:15], v[200:203], v[20:23]
    v_and_b32_dpp v12, v25, v8 row_newbcast:4 row_mask:0xf bank_mask:0xf
    v_and_b32_dpp v13, v25, v9 row_newbcast:4 row_mask:0xf bank_mask:0xf
    v_and_b32_dpp v14, v25, v10 row_newbcast:4 row_mask:0xf bank_mask:0xf
    v_and_b32_dpp v15, v25, v11 row_newbcast:4 row_mask:0xf bank_mask:0xf
    s_waitcnt vmcnt(4)
    buffer_load_dwordx4 v[224:227], v1, s[36:39], s76 offen nt
    s_addk_i32 s76, 0x1000
    v_mfma_f32_16x16x32_bf16 v[20:23], v[16:19], v[204:207], v[20:23]
    v_and_b32_dpp v16, v25, v8 row_newbcast:5 row_mask:0xf bank_mask:0xf
    v_and_b32_dpp v17, v25, v9 row_newbcast:5 row_mask:0xf bank_mask:0xf
    v_and_b32_dpp v18, v25, v10 row_newbcast:5 row_mask:0xf bank_mask:0xf
    v_and_b32_dpp v19, v25, v11 row_newbcast:5 row_mask:0xf bank_mask:0xf
    s_waitcnt vmcnt(4)
    buffer_load_dwordx4 v[228:231], v1, s[36:39], s76 offen nt
    s_addk_i32 s76, 0x1000
    v_mfma_f32_16x16x32_bf16 v[20:23], v[12:15], v[208:211], v[20:23]
    v_and_b32_dpp v12, v25, v8 row_newbcast:6 row_mask:0xf bank_mask:0xf
    v_and_b32_dpp v13, v25, v9 row_newbcast:6 row_mask:0xf bank_mask:0xf
    v_and_b32_dpp v14, v25, v10 row_newbcast:6 row_mask:0xf bank_mask:0xf
    v_and_b32_dpp v15, v25, v11 row_newbcast:6 row_mask:0xf bank_mask:0xf
    s_waitcnt vmcnt(4)
    buffer_load_dwordx4 v[232:235], v1, s[36:39], s76 offen nt
    s_addk_i32 s76, 0x1000
    v_mfma_f32_16x16x32_bf16 v[20:23], v[16:19], v[212:215], v[20:23]
    v_and_b32_dpp v16, v25, v8 row_newbcast:7 row_mask:0xf bank_mask:0xf
    v_and_b32_dpp v17, v25, v9 row_newbcast:7 row_mask:0xf bank_mask:0xf
    v_and_b32_dpp v18, v25, v10 row_newbcast:7 row_mask:0xf bank_mask:0xf
    v_and_b32_dpp v19, v25, v11 row_newbcast:7 row_mask:0xf bank_mask:0xf
    s_waitcnt vmcnt(4)
    buffer_load_dwordx4 v[236:239], v1, s[36:39], s76 offen nt
    s_addk_i32 s76, 0x1000
    v_mfma_f32_16x16x32_bf16 v[20:23], v[12:15], v[216:219], v[20:23]
    v_and_b32_dpp v12, v25, v8 row_newbcast:8 row_mask:0xf bank_mask:0xf
    v_and_b32_dpp v13, v25, v9 row_newbcast:8 row_mask:0xf bank_mask:0xf
    v_and_b32_dpp v14, v25, v10 row_newbcast:8 row_mask:0xf bank_mask:0xf
    v_and_b32_dpp v15, v25, v11 row_newbcast:8 row_mask:0xf bank_mask:0xf
    s_waitcnt vmcnt(4)
    buffer_load_dwordx4 v[240:243], v1, s[36:39], s76 offen nt
    s_addk_i32 s76, 0x1000
    v_mfma_f32_16x16x32_bf16 v[20:23], v[16:19], v[220:223], v[20:23]
    v_and_b32_dpp v16, v25, v8 row_newbcast:9 row_mask:0xf bank_mask:0xf
    v_and_b32_dpp v17, v25, v9 row_newbcast:9 row_mask:0xf bank_mask:0xf
    v_and_b32_dpp v18, v25, v10 row_newbcast:9 row_mask:0xf bank_mask:0xf
    v_and_b32_dpp v19, v25, v11 row_newbcast:9 row_mask:0xf bank_mask:0xf
    s_waitcnt vmcnt(4)
    buffer_load_dwordx4 v[244:247], v1, s[36:39], s76 offen nt
    s_addk_i32 s76, 0x1000
    v_mfma_f32_16x16x32_bf16 v[20:23], v[12:15], v[224:227], v[20:23]
    v_and_b32_dpp v12, v25, v8 row_newbcast:10 row_mask:0xf bank_mask:0xf
    v_and_b32_dpp v13, v25, v9 row_newbcast:10 row_mask:0xf bank_mask:0xf
    v_and_b32_dpp v14, v25, v10 row_newbcast:10 row_mask:0xf bank_mask:0xf
    v_and_b32_dpp v15, v25, v11 row_newbcast:10 row_mask:0xf bank_mask:0xf
    s_waitcnt vmcnt(4)
    buffer_load_dwordx4 v[248:251], v1, s[36:39], s76 offen nt
    s_addk_i32 s76, 0x1000
    v_mfma_f32_16x16x32_bf16 v[20:23], v[16:19], v[228:231], v[20:23]
    v_and_b32_dpp v16, v25, v8 row_newbcast:11 row_mask:0xf bank_mask:0xf
    v_and_b32_dpp v17, v25, v9 row_newbcast:11 row_mask:0xf bank_mask:0xf
    v_and_b32_dpp v18, v25, v10 row_newbcast:11 row_mask:0xf bank_mask:0xf
    v_and_b32_dpp v19, v25, v11 row_newbcast:11 row_mask:0xf bank_mask:0xf
    s_waitcnt vmcnt(4)
    buffer_load_dwordx4 v[252:255], v1, s[36:39], s76 offen nt
    s_addk_i32 s76, 0x1000
    v_mfma_f32_16x16x32_bf16 v[20:23], v[12:15], v[232:235], v[20:23]
    v_and_b32_dpp v12, v25, v8 row_newbcast:12 row_mask:0xf bank_mask:0xf
    v_and_b32_dpp v13, v25, v9 row_newbcast:12 row_mask:0xf bank_mask:0xf
    v_and_b32_dpp v14, v25, v10 row_newbcast:12 row_mask:0xf bank_mask:0xf
    v_and_b32_dpp v15, v25, v11 row_newbcast:12 row_mask:0xf bank_mask:0xf
    s_waitcnt vmcnt(4)
    buffer_load_dwordx4 v[64:67], v1, s[36:39], s76 offen nt
    s_addk_i32 s76, 0x1000
    v_mfma_f32_16x16x32_bf16 v[20:23], v[16:19], v[236:239], v[20:23]
    v_and_b32_dpp v16, v25, v8 row_newbcast:13 row_mask:0xf bank_mask:0xf
    v_and_b32_dpp v17, v25, v9 row_newbcast:13 row_mask:0xf bank_mask:0xf
    v_and_b32_dpp v18, v25, v10 row_newbcast:13 row_mask:0xf bank_mask:0xf
    v_and_b32_dpp v19, v25, v11 row_newbcast:13 row_mask:0xf bank_mask:0xf
    s_waitcnt vmcnt(4)
    buffer_load_dwordx4 v[68:71], v1, s[36:39], s76 offen nt
    s_addk_i32 s76, 0x1000
    v_mfma_f32_16x16x32_bf16 v[20:23], v[12:15], v[240:243], v[20:23]
    v_and_b32_dpp v12, v25, v8 row_newbcast:14 row_mask:0xf bank_mask:0xf
    v_and_b32_dpp v13, v25, v9 row_newbcast:14 row_mask:0xf bank_mask:0xf
    v_and_b32_dpp v14, v25, v10 row_newbcast:14 row_mask:0xf bank_mask:0xf
    v_and_b32_dpp v15, v25, v11 row_newbcast:14 row_mask:0xf bank_mask:0xf
    s_waitcnt vmcnt(4)
    buffer_load_dwordx4 v[72:75], v1, s[36:39], s76 offen nt
    s_addk_i32 s76, 0x1000
    v_mfma_f32_16x16x32_bf16 v[20:23], v[16:19], v[244:247], v[20:23]
    v_and_b32_dpp v16, v25, v8 row_newbcast:15 row_mask:0xf bank_mask:0xf
    v_and_b32_dpp v17, v25, v9 row_newbcast:15 row_mask:0xf bank_mask:0xf
    v_and_b32_dpp v18, v25, v10 row_newbcast:15 row_mask:0xf bank_mask:0xf
    v_and_b32_dpp v19, v25, v11 row_newbcast:15 row_mask:0xf bank_mask:0xf
    s_waitcnt vmcnt(4)
    buffer_load_dwordx4 v[76:79], v1, s[36:39], s76 offen nt
    s_addk_i32 s76, 0x1000
    v_mfma_f32_16x16x32_bf16 v[20:23], v[12:15], v[248:251], v[20:23]
    v_and_b32_dpp v12, v26, v8 row_newbcast:0 row_mask:0xf bank_mask:0xf
    v_and_b32_dpp v13, v26, v9 row_newbcast:0 row_mask:0xf bank_mask:0xf
    v_and_b32_dpp v14, v26, v10 row_newbcast:0 row_mask:0xf bank_mask:0xf
    v_and_b32_dpp v15, v26, v11 row_newbcast:0 row_mask:0xf bank_mask:0xf
    s_waitcnt vmcnt(4)
    buffer_load_dwordx4 v[80:83], v1, s[36:39], s76 offen nt
    s_addk_i32 s76, 0x1000
    v_mfma_f32_16x16x32_bf16 v[20:23], v[16:19], v[252:255], v[20:23]
    v_and_b32_dpp v16, v26, v8 row_newbcast:1 row_mask:0xf bank_mask:0xf
    v_and_b32_dpp v17, v26, v9 row_newbcast:1 row_mask:0xf bank_mask:0xf
    v_and_b32_dpp v18, v26, v10 row_newbcast:1 row_mask:0xf bank_mask:0xf
    v_and_b32_dpp v19, v26, v11 row_newbcast:1 row_mask:0xf bank_mask:0xf
    s_waitcnt vmcnt(4)
    buffer_load_dwordx4 v[84:87], v1, s[36:39], s76 offen nt
    s_addk_i32 s76, 0x1000
    v_mfma_f32_16x16x32_bf16 v[20:23], v[12:15], v[64:67], v[20:23]
    v_and_b32_dpp v12, v26, v8 row_newbcast:2 row_mask:0xf bank_mask:0xf
    v_and_b32_dpp v13, v26, v9 row_newbcast:2 row_mask:0xf bank_mask:0xf
    v_and_b32_dpp v14, v26, v10 row_newbcast:2 row_mask:0xf bank_mask:0xf
    v_and_b32_dpp v15, v26, v11 row_newbcast:2 row_mask:0xf bank_mask:0xf
    s_waitcnt vmcnt(4)
    buffer_load_dwordx4 v[88:91], v1, s[36:39], s76 offen nt
    s_addk_i32 s76, 0x1000
    v_mfma_f32_16x16x32_bf16 v[20:23], v[16:19], v[68:71], v[20:23]
    v_and_b32_dpp v16, v26, v8 row_newbcast:3 row_mask:0xf bank_mask:0xf
    v_and_b32_dpp v17, v26, v9 row_newbcast:3 row_mask:0xf bank_mask:0xf
    v_and_b32_dpp v18, v26, v10 row_newbcast:3 row_mask:0xf bank_mask:0xf
    v_and_b32_dpp v19, v26, v11 row_newbcast:3 row_mask:0xf bank_mask:0xf
    s_waitcnt vmcnt(4)
    buffer_load_dwordx4 v[92:95], v1, s[36:39], s76 offen nt
    s_addk_i32 s76, 0x1000
    v_mfma_f32_16x16x32_bf16 v[20:23], v[12:15], v[72:75], v[20:23]
    v_and_b32_dpp v12, v26, v8 row_newbcast:4 row_mask:0xf bank_mask:0xf
    v_and_b32_dpp v13, v26, v9 row_newbcast:4 row_mask:0xf bank_mask:0xf
    v_and_b32_dpp v14, v26, v10 row_newbcast:4 row_mask:0xf bank_mask:0xf
    v_and_b32_dpp v15, v26, v11 row_newbcast:4 row_mask:0xf bank_mask:0xf
    s_waitcnt vmcnt(4)
    buffer_load_dwordx4 v[96:99], v1, s[36:39], s76 offen nt
    s_addk_i32 s76, 0x1000
    v_mfma_f32_16x16x32_bf16 v[20:23], v[16:19], v[76:79], v[20:23]
    v_and_b32_dpp v16, v26, v8 row_newbcast:5 row_mask:0xf bank_mask:0xf
    v_and_b32_dpp v17, v26, v9 row_newbcast:5 row_mask:0xf bank_mask:0xf
    v_and_b32_dpp v18, v26, v10 row_newbcast:5 row_mask:0xf bank_mask:0xf
    v_and_b32_dpp v19, v26, v11 row_newbcast:5 row_mask:0xf bank_mask:0xf
    s_waitcnt vmcnt(4)
    buffer_load_dwordx4 v[100:103], v1, s[36:39], s76 offen nt
    s_addk_i32 s76, 0x1000
    v_mfma_f32_16x16x32_bf16 v[20:23], v[12:15], v[80:83], v[20:23]
    v_and_b32_dpp v12, v26, v8 row_newbcast:6 row_mask:0xf bank_mask:0xf
    v_and_b32_dpp v13, v26, v9 row_newbcast:6 row_mask:0xf bank_mask:0xf
    v_and_b32_dpp v14, v26, v10 row_newbcast:6 row_mask:0xf bank_mask:0xf
    v_and_b32_dpp v15, v26, v11 row_newbcast:6 row_mask:0xf bank_mask:0xf
    s_waitcnt vmcnt(4)
    buffer_load_dwordx4 v[104:107], v1, s[36:39], s76 offen nt
    s_addk_i32 s76, 0x1000
    v_mfma_f32_16x16x32_bf16 v[20:23], v[16:19], v[84:87], v[20:23]
    v_and_b32_dpp v16, v26, v8 row_newbcast:7 row_mask:0xf bank_mask:0xf
    v_and_b32_dpp v17, v26, v9 row_newbcast:7 row_mask:0xf bank_mask:0xf
    v_and_b32_dpp v18, v26, v10 row_newbcast:7 row_mask:0xf bank_mask:0xf
    v_and_b32_dpp v19, v26, v11 row_newbcast:7 row_mask:0xf bank_mask:0xf
    s_waitcnt vmcnt(4)
    buffer_load_dwordx4 v[108:111], v1, s[36:39], s76 offen nt
    s_addk_i32 s76, 0x1000
    v_mfma_f32_16x16x32_bf16 v[20:23], v[12:15], v[88:91], v[20:23]
    v_and_b32_dpp v12, v26, v8 row_newbcast:8 row_mask:0xf bank_mask:0xf
    v_and_b32_dpp v13, v26, v9 row_newbcast:8 row_mask:0xf bank_mask:0xf
    v_and_b32_dpp v14, v26, v10 row_newbcast:8 row_mask:0xf bank_mask:0xf
    v_and_b32_dpp v15, v26, v11 row_newbcast:8 row_mask:0xf bank_mask:0xf
    s_waitcnt vmcnt(4)
    buffer_load_dwordx4 v[112:115], v1, s[36:39], s76 offen nt
    s_addk_i32 s76, 0x1000
    v_mfma_f32_16x16x32_bf16 v[20:23], v[16:19], v[92:95], v[20:23]
    v_and_b32_dpp v16, v26, v8 row_newbcast:9 row_mask:0xf bank_mask:0xf
    v_and_b32_dpp v17, v26, v9 row_newbcast:9 row_mask:0xf bank_mask:0xf
    v_and_b32_dpp v18, v26, v10 row_newbcast:9 row_mask:0xf bank_mask:0xf
    v_and_b32_dpp v19, v26, v11 row_newbcast:9 row_mask:0xf bank_mask:0xf
    s_waitcnt vmcnt(4)
    buffer_load_dwordx4 v[116:119], v1, s[36:39], s76 offen nt
    s_addk_i32 s76, 0x1000
    v_mfma_f32_16x16x32_bf16 v[20:23], v[12:15], v[96:99], v[20:23]
    v_and_b32_dpp v12, v26, v8 row_newbcast:10 row_mask:0xf bank_mask:0xf
    v_and_b32_dpp v13, v26, v9 row_newbcast:10 row_mask:0xf bank_mask:0xf
    v_and_b32_dpp v14, v26, v10 row_newbcast:10 row_mask:0xf bank_mask:0xf
    v_and_b32_dpp v15, v26, v11 row_newbcast:10 row_mask:0xf bank_mask:0xf
    s_waitcnt vmcnt(4)
    buffer_load_dwordx4 v[120:123], v1, s[36:39], s76 offen nt
    s_addk_i32 s76, 0x1000
    v_mfma_f32_16x16x32_bf16 v[20:23], v[16:19], v[100:103], v[20:23]
    v_and_b32_dpp v16, v26, v8 row_newbcast:11 row_mask:0xf bank_mask:0xf
    v_and_b32_dpp v17, v26, v9 row_newbcast:11 row_mask:0xf bank_mask:0xf
    v_and_b32_dpp v18, v26, v10 row_newbcast:11 row_mask:0xf bank_mask:0xf
    v_and_b32_dpp v19, v26, v11 row_newbcast:11 row_mask:0xf bank_mask:0xf
    s_waitcnt vmcnt(4)
    buffer_load_dwordx4 v[124:127], v1, s[36:39], s76 offen nt
    s_addk_i32 s76, 0x1000
    v_mfma_f32_16x16x32_bf16 v[20:23], v[12:15], v[104:107], v[20:23]
    v_and_b32_dpp v12, v26, v8 row_newbcast:12 row_mask:0xf bank_mask:0xf
    v_and_b32_dpp v13, v26, v9 row_newbcast:12 row_mask:0xf bank_mask:0xf
    v_and_b32_dpp v14, v26, v10 row_newbcast:12 row_mask:0xf bank_mask:0xf
    v_and_b32_dpp v15, v26, v11 row_newbcast:12 row_mask:0xf bank_mask:0xf
    s_waitcnt vmcnt(4)
    buffer_load_dwordx4 v[128:131], v1, s[36:39], s76 offen nt
    s_addk_i32 s76, 0x1000
    v_mfma_f32_16x16x32_bf16 v[20:23], v[16:19], v[108:111], v[20:23]
    v_and_b32_dpp v16, v26, v8 row_newbcast:13 row_mask:0xf bank_mask:0xf
    v_and_b32_dpp v17, v26, v9 row_newbcast:13 row_mask:0xf bank_mask:0xf
    v_and_b32_dpp v18, v26, v10 row_newbcast:13 row_mask:0xf bank_mask:0xf
    v_and_b32_dpp v19, v26, v11 row_newbcast:13 row_mask:0xf bank_mask:0xf
    s_waitcnt vmcnt(4)
    buffer_load_dwordx4 v[132:135], v1, s[36:39], s76 offen nt
    s_addk_i32 s76, 0x1000
    v_mfma_f32_16x16x32_bf16 v[20:23], v[12:15], v[112:115], v[20:23]
    v_and_b32_dpp v12, v26, v8 row_newbcast:14 row_mask:0xf bank_mask:0xf
    v_and_b32_dpp v13, v26, v9 row_newbcast:14 row_mask:0xf bank_mask:0xf
    v_and_b32_dpp v14, v26, v10 row_newbcast:14 row_mask:0xf bank_mask:0xf
    v_and_b32_dpp v15, v26, v11 row_newbcast:14 row_mask:0xf bank_mask:0xf
    s_waitcnt vmcnt(4)
    buffer_load_dwordx4 v[136:139], v1, s[36:39], s76 offen nt
    s_addk_i32 s76, 0x1000
    v_mfma_f32_16x16x32_bf16 v[20:23], v[16:19], v[116:119], v[20:23]
    v_and_b32_dpp v16, v26, v8 row_newbcast:15 row_mask:0xf bank_mask:0xf
    v_and_b32_dpp v17, v26, v9 row_newbcast:15 row_mask:0xf bank_mask:0xf
    v_and_b32_dpp v18, v26, v10 row_newbcast:15 row_mask:0xf bank_mask:0xf
    v_and_b32_dpp v19, v26, v11 row_newbcast:15 row_mask:0xf bank_mask:0xf
    s_waitcnt vmcnt(4)
    buffer_load_dwordx4 v[140:143], v1, s[36:39], s76 offen nt
    s_addk_i32 s76, 0x1000
    v_mfma_f32_16x16x32_bf16 v[20:23], v[12:15], v[120:123], v[20:23]
    v_and_b32_dpp v12, v27, v8 row_newbcast:0 row_mask:0xf bank_mask:0xf
    v_and_b32_dpp v13, v27, v9 row_newbcast:0 row_mask:0xf bank_mask:0xf
    v_and_b32_dpp v14, v27, v10 row_newbcast:0 row_mask:0xf bank_mask:0xf
    v_and_b32_dpp v15, v27, v11 row_newbcast:0 row_mask:0xf bank_mask:0xf
    s_waitcnt vmcnt(4)
    buffer_load_dwordx4 v[144:147], v1, s[36:39], s76 offen nt
    s_addk_i32 s76, 0x1000
    v_mfma_f32_16x16x32_bf16 v[20:23], v[16:19], v[124:127], v[20:23]
    v_and_b32_dpp v16, v27, v8 row_newbcast:1 row_mask:0xf bank_mask:0xf
    v_and_b32_dpp v17, v27, v9 row_newbcast:1 row_mask:0xf bank_mask:0xf
    v_and_b32_dpp v18, v27, v10 row_newbcast:1 row_mask:0xf bank_mask:0xf
    v_and_b32_dpp v19, v27, v11 row_newbcast:1 row_mask:0xf bank_mask:0xf
    s_waitcnt vmcnt(4)
    buffer_load_dwordx4 v[148:151], v1, s[36:39], s76 offen nt
    s_addk_i32 s76, 0x1000
    v_mfma_f32_16x16x32_bf16 v[20:23], v[12:15], v[128:131], v[20:23]
    v_and_b32_dpp v12, v27, v8 row_newbcast:2 row_mask:0xf bank_mask:0xf
    v_and_b32_dpp v13, v27, v9 row_newbcast:2 row_mask:0xf bank_mask:0xf
    v_and_b32_dpp v14, v27, v10 row_newbcast:2 row_mask:0xf bank_mask:0xf
    v_and_b32_dpp v15, v27, v11 row_newbcast:2 row_mask:0xf bank_mask:0xf
    s_waitcnt vmcnt(4)
    buffer_load_dwordx4 v[152:155], v1, s[36:39], s76 offen nt
    s_addk_i32 s76, 0x1000
    v_mfma_f32_16x16x32_bf16 v[20:23], v[16:19], v[132:135], v[20:23]
    v_and_b32_dpp v16, v27, v8 row_newbcast:3 row_mask:0xf bank_mask:0xf
    v_and_b32_dpp v17, v27, v9 row_newbcast:3 row_mask:0xf bank_mask:0xf
    v_and_b32_dpp v18, v27, v10 row_newbcast:3 row_mask:0xf bank_mask:0xf
    v_and_b32_dpp v19, v27, v11 row_newbcast:3 row_mask:0xf bank_mask:0xf
    s_waitcnt vmcnt(4)
    buffer_load_dwordx4 v[156:159], v1, s[36:39], s76 offen nt
    s_addk_i32 s76, 0x1000
    v_mfma_f32_16x16x32_bf16 v[20:23], v[12:15], v[136:139], v[20:23]
    v_and_b32_dpp v12, v27, v8 row_newbcast:4 row_mask:0xf bank_mask:0xf
    v_and_b32_dpp v13, v27, v9 row_newbcast:4 row_mask:0xf bank_mask:0xf
    v_and_b32_dpp v14, v27, v10 row_newbcast:4 row_mask:0xf bank_mask:0xf
    v_and_b32_dpp v15, v27, v11 row_newbcast:4 row_mask:0xf bank_mask:0xf
    s_waitcnt vmcnt(4)
    buffer_load_dwordx4 v[160:163], v1, s[36:39], s76 offen nt
    s_addk_i32 s76, 0x1000
    v_mfma_f32_16x16x32_bf16 v[20:23], v[16:19], v[140:143], v[20:23]
    v_and_b32_dpp v16, v27, v8 row_newbcast:5 row_mask:0xf bank_mask:0xf
    v_and_b32_dpp v17, v27, v9 row_newbcast:5 row_mask:0xf bank_mask:0xf
    v_and_b32_dpp v18, v27, v10 row_newbcast:5 row_mask:0xf bank_mask:0xf
    v_and_b32_dpp v19, v27, v11 row_newbcast:5 row_mask:0xf bank_mask:0xf
    s_waitcnt vmcnt(4)
    buffer_load_dwordx4 v[164:167], v1, s[36:39], s76 offen nt
    s_addk_i32 s76, 0x1000
    v_mfma_f32_16x16x32_bf16 v[20:23], v[12:15], v[144:147], v[20:23]
    v_and_b32_dpp v12, v27, v8 row_newbcast:6 row_mask:0xf bank_mask:0xf
    v_and_b32_dpp v13, v27, v9 row_newbcast:6 row_mask:0xf bank_mask:0xf
    v_and_b32_dpp v14, v27, v10 row_newbcast:6 row_mask:0xf bank_mask:0xf
    v_and_b32_dpp v15, v27, v11 row_newbcast:6 row_mask:0xf bank_mask:0xf
    s_waitcnt vmcnt(4)
    buffer_load_dwordx4 v[168:171], v1, s[36:39], s76 offen nt
    s_addk_i32 s76, 0x1000
    v_mfma_f32_16x16x32_bf16 v[20:23], v[16:19], v[148:151], v[20:23]
    v_and_b32_dpp v16, v27, v8 row_newbcast:7 row_mask:0xf bank_mask:0xf
    v_and_b32_dpp v17, v27, v9 row_newbcast:7 row_mask:0xf bank_mask:0xf
    v_and_b32_dpp v18, v27, v10 row_newbcast:7 row_mask:0xf bank_mask:0xf
    v_and_b32_dpp v19, v27, v11 row_newbcast:7 row_mask:0xf bank_mask:0xf
    s_waitcnt vmcnt(4)
    buffer_load_dwordx4 v[172:175], v1, s[36:39], s76 offen nt
    s_addk_i32 s76, 0x1000
    v_mfma_f32_16x16x32_bf16 v[20:23], v[12:15], v[152:155], v[20:23]
    v_and_b32_dpp v12, v27, v8 row_newbcast:8 row_mask:0xf bank_mask:0xf
    v_and_b32_dpp v13, v27, v9 row_newbcast:8 row_mask:0xf bank_mask:0xf
    v_and_b32_dpp v14, v27, v10 row_newbcast:8 row_mask:0xf bank_mask:0xf
    v_and_b32_dpp v15, v27, v11 row_newbcast:8 row_mask:0xf bank_mask:0xf
    s_waitcnt vmcnt(4)
    buffer_load_dwordx4 v[176:179], v1, s[36:39], s76 offen nt
    s_addk_i32 s76, 0x1000
    v_mfma_f32_16x16x32_bf16 v[20:23], v[16:19], v[156:159], v[20:23]
    v_and_b32_dpp v16, v27, v8 row_newbcast:9 row_mask:0xf bank_mask:0xf
    v_and_b32_dpp v17, v27, v9 row_newbcast:9 row_mask:0xf bank_mask:0xf
    v_and_b32_dpp v18, v27, v10 row_newbcast:9 row_mask:0xf bank_mask:0xf
    v_and_b32_dpp v19, v27, v11 row_newbcast:9 row_mask:0xf bank_mask:0xf
    s_waitcnt vmcnt(4)
    buffer_load_dwordx4 v[180:183], v1, s[36:39], s76 offen nt
    s_addk_i32 s76, 0x1000
    v_mfma_f32_16x16x32_bf16 v[20:23], v[12:15], v[160:163], v[20:23]
    v_and_b32_dpp v12, v27, v8 row_newbcast:10 row_mask:0xf bank_mask:0xf
    v_and_b32_dpp v13, v27, v9 row_newbcast:10 row_mask:0xf bank_mask:0xf
    v_and_b32_dpp v14, v27, v10 row_newbcast:10 row_mask:0xf bank_mask:0xf
    v_and_b32_dpp v15, v27, v11 row_newbcast:10 row_mask:0xf bank_mask:0xf
    s_waitcnt vmcnt(4)
    buffer_load_dwordx4 v[184:187], v1, s[36:39], s76 offen nt
    s_addk_i32 s76, 0x1000
    v_mfma_f32_16x16x32_bf16 v[20:23], v[16:19], v[164:167], v[20:23]
    v_and_b32_dpp v16, v27, v8 row_newbcast:11 row_mask:0xf bank_mask:0xf
    v_and_b32_dpp v17, v27, v9 row_newbcast:11 row_mask:0xf bank_mask:0xf
    v_and_b32_dpp v18, v27, v10 row_newbcast:11 row_mask:0xf bank_mask:0xf
    v_and_b32_dpp v19, v27, v11 row_newbcast:11 row_mask:0xf bank_mask:0xf
    s_waitcnt vmcnt(4)
    buffer_load_dwordx4 v[188:191], v1, s[36:39], s76 offen nt
    s_addk_i32 s76, 0x1000
    s_barrier
    v_mfma_f32_16x16x32_bf16 v[20:23], v[12:15], v[168:171], v[20:23]
    v_and_b32_dpp v12, v27, v8 row_newbcast:12 row_mask:0xf bank_mask:0xf
    v_and_b32_dpp v13, v27, v9 row_newbcast:12 row_mask:0xf bank_mask:0xf
    v_and_b32_dpp v14, v27, v10 row_newbcast:12 row_mask:0xf bank_mask:0xf
    v_and_b32_dpp v15, v27, v11 row_newbcast:12 row_mask:0xf bank_mask:0xf
    s_waitcnt vmcnt(4)
    v_mfma_f32_16x16x32_bf16 v[20:23], v[16:19], v[172:175], v[20:23]
    v_and_b32_dpp v16, v27, v8 row_newbcast:13 row_mask:0xf bank_mask:0xf
    v_and_b32_dpp v17, v27, v9 row_newbcast:13 row_mask:0xf bank_mask:0xf
    v_and_b32_dpp v18, v27, v10 row_newbcast:13 row_mask:0xf bank_mask:0xf
    v_and_b32_dpp v19, v27, v11 row_newbcast:13 row_mask:0xf bank_mask:0xf
    s_waitcnt vmcnt(3)
    v_mfma_f32_16x16x32_bf16 v[20:23], v[12:15], v[176:179], v[20:23]
    v_and_b32_dpp v12, v27, v8 row_newbcast:14 row_mask:0xf bank_mask:0xf
    v_and_b32_dpp v13, v27, v9 row_newbcast:14 row_mask:0xf bank_mask:0xf
    v_and_b32_dpp v14, v27, v10 row_newbcast:14 row_mask:0xf bank_mask:0xf
    v_and_b32_dpp v15, v27, v11 row_newbcast:14 row_mask:0xf bank_mask:0xf
    s_waitcnt vmcnt(2)
    v_mfma_f32_16x16x32_bf16 v[20:23], v[16:19], v[180:183], v[20:23]
    v_and_b32_dpp v16, v27, v8 row_newbcast:15 row_mask:0xf bank_mask:0xf
    v_and_b32_dpp v17, v27, v9 row_newbcast:15 row_mask:0xf bank_mask:0xf
    v_and_b32_dpp v18, v27, v10 row_newbcast:15 row_mask:0xf bank_mask:0xf
    v_and_b32_dpp v19, v27, v11 row_newbcast:15 row_mask:0xf bank_mask:0xf
    s_waitcnt vmcnt(1)
    v_mfma_f32_16x16x32_bf16 v[20:23], v[12:15], v[184:187], v[20:23]
    s_waitcnt vmcnt(0)
    v_mfma_f32_16x16x32_bf16 v[20:23], v[16:19], v[188:191], v[20:23]
    s_nop 7
    ds_write_b128 v1, v[20:23] offset:1024
    s_waitcnt lgkmcnt(0)
    s_barrier
    s_endpgm
.section .rodata,"a"
.p2align 6
.amdhsa_kernel parallel_sum__mha_block_cached__geglu_ffn__decode_kernel
  .amdhsa_next_free_vgpr 256
  .amdhsa_next_free_sgpr 102
  .amdhsa_accum_offset 256
  .amdhsa_group_segment_fixed_size 0
  .amdhsa_kernarg_size 96
  .amdhsa_user_sgpr_count 2
  .amdhsa_user_sgpr_kernarg_segment_ptr 1
  .amdhsa_system_sgpr_workgroup_id_x 1
.end_amdhsa_kernel
```
